```python
import torch

def _softmax(x, axis=-1):
    return torch.softmax(x, dim=axis)
def _gelu(x):
    return torch.nn.functional.gelu(x, approximate="tanh")
def _silu(x):
    return torch.nn.functional.silu(x)
def _sigmoid(x):
    return torch.sigmoid(x)
def _layernorm(x, axis=-1, eps=1e-5):
    m = x.mean(dim=axis, keepdim=True)
    v = x.var(dim=axis, keepdim=True, unbiased=False)
    return (x - m) / torch.sqrt(v + eps)
def _scatter_add(tgt, idx, src, axis=0):
    return tgt.clone().index_add_(axis, idx, src)
def _segment_sum(src, seg, n):
    out = torch.zeros((n,) + src.shape[1:], dtype=src.dtype)
    return out.index_add_(0, seg, src)
def _pad(x, pw):
    flat = tuple(v for pair in reversed(pw) for v in pair)
    return torch.nn.functional.pad(x, flat)

kernel_name = 'concat_heads__sliding_block__mha_block__prompt'

def setup_inputs():

    _w = (lambda a: (lambda t: t.to(torch.bfloat16) if t.is_floating_point() else t)(torch.as_tensor(a)))
    def _A_setup():
        B, S, D = 1, 2048, 640
        return {
            "x": _w((lambda *s: torch.randn(*s, dtype=torch.bfloat16) * 0.4)(B, S, D)),
            "wqkv": _w((lambda *s: torch.randn(*s, dtype=torch.bfloat16) * 0.4)(D, 3 * D)),
            "wo": _w((lambda *s: torch.randn(*s, dtype=torch.bfloat16) * 0.05)(D, D)),
        }
    _A_in = _A_setup()

    def _B_setup():
        B, S, D, H = 1, 2048, 640, 32
        return {
            "x": _w((lambda *s: torch.randn(*s, dtype=torch.bfloat16) * 0.2)(B, S, D)),
            "wqkv": _w((lambda *s: torch.randn(*s, dtype=torch.bfloat16) * 0.4)(D, 3 * D)),
            "wo": _w((lambda *s: torch.randn(*s, dtype=torch.bfloat16) * 0.1)(D, D)),
        }
    _B_in = _B_setup()

    return {
        "A_x": _A_in["x"],
        "A_wqkv": _A_in["wqkv"],
        "A_wo": _A_in["wo"],
        "B_x": _B_in["x"],
        "B_wqkv": _B_in["wqkv"],
        "B_wo": _B_in["wo"],
    }

def reference(A_x, A_wqkv, A_wo, B_x, B_wqkv, B_wo):
    def _A_ref(x, wqkv, wo):
        B, S, D = x.shape
        H = 32; Dh = D // H; W = 256
        qkv = (lambda x, *d: x.permute(*d))((x @ wqkv).reshape(B, S, 3, H, Dh), 2, 0, 3, 1, 4)
        q, k, v = qkv[0], qkv[1], qkv[2]
        scores = torch.einsum("bhqd,bhkd->bhqk", q, k) * (Dh ** -0.5)
        idx = torch.arange(S)
        mask = (idx[:, None] - idx[None, :] >= 0) & (idx[:, None] - idx[None, :] < W)
        scores = torch.where(mask[None, None], scores, -1e9)
        p = _softmax(scores, axis=-1)
        o = torch.einsum("bhqk,bhkd->bhqd", p, v)
        return (lambda x, *d: x.permute(*d))(o, 0, 2, 1, 3).reshape(B, S, D) @ wo

    def _B_ref(x, wqkv, wo):
        B, S, D = x.shape
        H = 32
        Dh = D // H
        qkv = (lambda x, *d: x.permute(*d))((x @ wqkv).reshape(B, S, 3, H, Dh), 2, 0, 3, 1, 4)
        q, k, v = qkv[0], qkv[1], qkv[2]
        scores = torch.einsum("bhqd,bhkd->bhqk", q, k) * (Dh ** -0.5)
        p = _softmax(scores, axis=-1)
        o = torch.einsum("bhqk,bhkd->bhqd", p, v)
        return (lambda x, *d: x.permute(*d))(o, 0, 2, 1, 3).reshape(B, S, D) @ wo

    a = _A_ref(A_x, A_wqkv, A_wo)
    b = _B_ref(B_x, B_wqkv, B_wo)
    return torch.concatenate([a, b], axis=-1)
```

```asm
; @launch grid=(256,1,1) block=(768,1,1) lds=163840
.amdgcn_target "amdgcn-amd-amdhsa--gfx950"
.text
.globl concat_heads__sliding_block__mha_block__prompt_kernel
.p2align 8
.type concat_heads__sliding_block__mha_block__prompt_kernel,@function
concat_heads__sliding_block__mha_block__prompt_kernel:
  s_cmp_ge_u32 s2, 256
  s_cbranch_scc1 concat_heads__sliding_block__mha_block__prompt_kernel_END
  s_load_dwordx4 s[16:19], s[0:1], 0
  s_load_dwordx4 s[20:23], s[0:1], 24
  s_load_dwordx2 s[24:25], s[0:1], 16
  s_load_dwordx2 s[26:27], s[0:1], 40
  s_load_dwordx4 s[28:31], s[0:1], 48
  s_load_dwordx2 s[60:61], s[0:1], 64
  v_lshrrev_b32 v2, 6, v0
  v_and_b32 v1, 63, v0
  v_readfirstlane_b32 s32, v2
  s_and_b32 s36, s2, 7
  s_lshr_b32 s37, s2, 3
  s_and_b32 s34, s36, 3
  s_lshl_b32 s34, s34, 2
  s_and_b32 s38, s37, 3
  s_add_u32 s34, s34, s38
  s_lshr_b32 s35, s36, 2
  s_lshl_b32 s35, s35, 3
  s_lshr_b32 s38, s37, 2
  s_add_u32 s35, s35, s38
  s_cmp_lg_u32 s35, 15
  s_cselect_b32 s62, 1, 0
  s_mov_b32 s63, s34
  s_cmp_lt_u32 s32, 8
  s_cbranch_scc1 concat_heads__sliding_block__mha_block__prompt_kernel_compute
  s_sub_u32 s33, s32, 8
  s_cmp_eq_u32 s62, 0
  s_cbranch_scc0 concat_heads__sliding_block__mha_block__prompt_kernel_ld_q
  s_waitcnt lgkmcnt(0)
  s_mov_b32 s12, s60
  s_and_b32 s13, s61, 0xffff
  s_mov_b32 s14, 33554432
  s_mov_b32 s15, 0x20000
  s_barrier
  s_and_b32 s34, s2, 7
  s_lshr_b32 s35, s2, 3
  s_lshr_b32 s36, s35, 3
  s_lshl_b32 s34, s34, 2
  s_add_u32 s34, s34, s36
  s_and_b32 s35, s35, 7
  s_mul_i32 s36, s34, 1280
  s_mul_i32 s37, s34, 320
  s_add_u32 s37, s37, 40960
  s_movk_i32 s47, 3121
  v_add_u32 v2, 0, v1
  v_lshlrev_b32 v3, 4, v2
  v_add_u32 v4, s36, v3
  v_add_u32 v6, 39680, v4
  v_subrev_u32 v5, 80, v2
  v_and_b32 v5, 0xff, v5
  v_mul_u32_u24 v7, s47, v5
  v_lshrrev_b32 v7, 16, v7
  v_mul_u32_u24 v8, 21, v7
  v_sub_u32 v8, v5, v8
  v_mul_u32_u24 v7, 10240, v7
  v_lshl_add_u32 v7, v8, 4, v7
  v_add_u32 v7, s37, v7
  v_cmp_gt_u32 vcc, 80, v2
  s_nop 1
  v_cndmask_b32 v10, v7, v4, vcc
  v_cndmask_b32 v13, v6, v4, vcc
  v_add_u32 v2, 64, v1
  v_lshlrev_b32 v3, 4, v2
  v_add_u32 v4, s36, v3
  v_add_u32 v6, 39680, v4
  v_subrev_u32 v5, 80, v2
  v_and_b32 v5, 0xff, v5
  v_mul_u32_u24 v7, s47, v5
  v_lshrrev_b32 v7, 16, v7
  v_mul_u32_u24 v8, 21, v7
  v_sub_u32 v8, v5, v8
  v_mul_u32_u24 v7, 10240, v7
  v_lshl_add_u32 v7, v8, 4, v7
  v_add_u32 v7, s37, v7
  v_cmp_gt_u32 vcc, 80, v2
  s_nop 1
  v_cndmask_b32 v11, v7, v4, vcc
  v_cndmask_b32 v14, v6, v4, vcc
  v_cmp_gt_u32 s[56:57], 20, v8
  s_movk_i32 s55, 164
  v_cmp_gt_u32 s[58:59], s55, v2
  s_nop 1
  s_and_b64 s[56:57], s[56:57], s[58:59]
  s_or_b64 s[38:39], s[56:57], vcc
  v_add_u32 v2, 128, v1
  v_lshlrev_b32 v3, 4, v2
  v_add_u32 v4, s36, v3
  v_add_u32 v6, 39680, v4
  v_subrev_u32 v5, 80, v2
  v_and_b32 v5, 0xff, v5
  v_mul_u32_u24 v7, s47, v5
  v_lshrrev_b32 v7, 16, v7
  v_mul_u32_u24 v8, 21, v7
  v_sub_u32 v8, v5, v8
  v_mul_u32_u24 v7, 10240, v7
  v_lshl_add_u32 v7, v8, 4, v7
  v_add_u32 v7, s37, v7
  v_cmp_gt_u32 vcc, 80, v2
  s_nop 1
  v_cndmask_b32 v12, v7, v4, vcc
  v_cndmask_b32 v15, v6, v4, vcc
  v_cmp_gt_u32 s[56:57], 20, v8
  s_movk_i32 s55, 164
  v_cmp_gt_u32 s[58:59], s55, v2
  s_nop 1
  s_and_b64 s[56:57], s[56:57], s[58:59]
  s_or_b64 s[58:59], s[56:57], vcc
  s_mul_i32 s43, s33, 2624
  v_mov_b32 v20, 25165824
  s_mov_b32 s50, 0
  s_branch concat_heads__sliding_block__mha_block__prompt_kernel_a_late
concat_heads__sliding_block__mha_block__prompt_kernel_ld_q:
  v_lshrrev_b32 v2, 3, v1
  v_mul_u32_u24 v2, 1280, v2
  v_and_b32 v3, 7, v1
  v_lshrrev_b32 v4, 4, v1
  v_xor_b32 v3, v3, v4
  v_lshl_add_u32 v10, v3, 4, v2
  v_xor_b32 v3, 4, v3
  v_lshl_add_u32 v11, v3, 4, v2
  v_mul_u32_u24 v2, 3840, v4
  v_and_b32 v3, 15, v1
  v_lshlrev_b32 v5, 2, v4
  v_xor_b32 v3, v3, v5
  v_lshl_add_u32 v12, v3, 4, v2
  s_lshl_b32 s40, s34, 7
  s_lshl_b32 s39, s33, 5
  s_add_u32 s40, s40, s39
  s_mul_i32 s40, s40, 1280
  s_mul_i32 s41, s33, 61440
  s_lshl_b32 s39, s35, 8
  s_add_u32 s41, s41, s39
  s_lshl_b32 s42, s33, 12
  s_mov_b32 s43, 0
  s_mov_b32 s44, 0
  s_mov_b32 s54, 0x5055050
  s_and_b32 s55, s2, 7
  s_lshl_b32 s55, s55, 2
  s_lshr_b32 s54, s54, s55
  s_and_b32 s54, s54, 15
  s_lshr_b32 s55, s2, 3
  s_and_b32 s53, s55, 3
  s_mul_i32 s53, s53, 1
  s_add_u32 s54, s54, s53
  s_lshr_b32 s55, s55, 2
  s_mul_i32 s55, s55, 2
  s_add_u32 s54, s54, s55
  s_mul_i32 s55, s54, 205
  s_lshr_b32 s55, s55, 11
  s_mul_i32 s55, s55, 10
  s_sub_u32 s54, s54, s55
  s_mov_b32 s45, s54
  s_waitcnt lgkmcnt(0)
  s_mov_b32 s4, s20
  s_and_b32 s5, s21, 0xffff
  s_mov_b32 s6, 2621440
  s_mov_b32 s7, 0x20000
  s_mov_b32 s8, s22
  s_and_b32 s9, s23, 0xffff
  s_mov_b32 s10, 2457600
  s_mov_b32 s11, 0x20000
  s_cmp_eq_u32 s44, 10
  s_cbranch_scc0 qsw_1
  s_mov_b32 s4, s16
  s_and_b32 s5, s17, 0xffff
  s_mov_b32 s6, 2621440
  s_mov_b32 s7, 0x20000
  s_mov_b32 s8, s18
  s_and_b32 s9, s19, 0xffff
  s_mov_b32 s10, 2457600
  s_mov_b32 s11, 0x20000
  s_mov_b32 s45, s54
qsw_1:
  s_add_u32 s46, s43, s42
  s_mul_i32 s47, s45, 245760
  s_add_u32 s47, s47, s41
  s_lshl_b32 s48, s45, 7
  s_add_u32 s48, s48, s40
  s_add_u32 m0, s46, 16384
  s_add_u32 s49, s47, 0
  buffer_load_dwordx4 v12, s[8:11], s49 offen lds
  s_add_u32 m0, s46, 17408
  s_add_u32 s49, s47, 15360
  buffer_load_dwordx4 v12, s[8:11], s49 offen lds
  s_add_u32 m0, s46, 18432
  s_add_u32 s49, s47, 30720
  buffer_load_dwordx4 v12, s[8:11], s49 offen lds
  s_add_u32 m0, s46, 19456
  s_add_u32 s49, s47, 46080
  buffer_load_dwordx4 v12, s[8:11], s49 offen lds
  s_add_u32 m0, s46, 0
  s_add_u32 s49, s48, 0
  buffer_load_dwordx4 v10, s[4:7], s49 offen lds
  s_add_u32 m0, s46, 1024
  s_add_u32 s49, s48, 10240
  buffer_load_dwordx4 v11, s[4:7], s49 offen lds
  s_add_u32 m0, s46, 2048
  s_add_u32 s49, s48, 20480
  buffer_load_dwordx4 v10, s[4:7], s49 offen lds
  s_add_u32 m0, s46, 3072
  s_add_u32 s49, s48, 30720
  buffer_load_dwordx4 v11, s[4:7], s49 offen lds
  s_add_u32 s45, s45, 1
  s_cmp_eq_u32 s45, 10
  s_cselect_b32 s45, 0, s45
  s_add_u32 s44, s44, 1
  s_add_u32 s43, s43, 32768
  s_and_b32 s43, s43, 131071
  s_cmp_eq_u32 s44, 10
  s_cbranch_scc0 qsw_2
  s_mov_b32 s4, s16
  s_and_b32 s5, s17, 0xffff
  s_mov_b32 s6, 2621440
  s_mov_b32 s7, 0x20000
  s_mov_b32 s8, s18
  s_and_b32 s9, s19, 0xffff
  s_mov_b32 s10, 2457600
  s_mov_b32 s11, 0x20000
  s_mov_b32 s45, s54
qsw_2:
  s_add_u32 s46, s43, s42
  s_mul_i32 s47, s45, 245760
  s_add_u32 s47, s47, s41
  s_lshl_b32 s48, s45, 7
  s_add_u32 s48, s48, s40
  s_add_u32 m0, s46, 16384
  s_add_u32 s49, s47, 0
  buffer_load_dwordx4 v12, s[8:11], s49 offen lds
  s_add_u32 m0, s46, 17408
  s_add_u32 s49, s47, 15360
  buffer_load_dwordx4 v12, s[8:11], s49 offen lds
  s_add_u32 m0, s46, 18432
  s_add_u32 s49, s47, 30720
  buffer_load_dwordx4 v12, s[8:11], s49 offen lds
  s_add_u32 m0, s46, 19456
  s_add_u32 s49, s47, 46080
  buffer_load_dwordx4 v12, s[8:11], s49 offen lds
  s_add_u32 m0, s46, 0
  s_add_u32 s49, s48, 0
  buffer_load_dwordx4 v10, s[4:7], s49 offen lds
  s_add_u32 m0, s46, 1024
  s_add_u32 s49, s48, 10240
  buffer_load_dwordx4 v11, s[4:7], s49 offen lds
  s_add_u32 m0, s46, 2048
  s_add_u32 s49, s48, 20480
  buffer_load_dwordx4 v10, s[4:7], s49 offen lds
  s_add_u32 m0, s46, 3072
  s_add_u32 s49, s48, 30720
  buffer_load_dwordx4 v11, s[4:7], s49 offen lds
  s_add_u32 s45, s45, 1
  s_cmp_eq_u32 s45, 10
  s_cselect_b32 s45, 0, s45
  s_add_u32 s44, s44, 1
  s_add_u32 s43, s43, 32768
  s_and_b32 s43, s43, 131071
  s_mov_b32 s12, s60
  s_and_b32 s13, s61, 0xffff
  s_mov_b32 s14, 33554432
  s_mov_b32 s15, 0x20000
  s_waitcnt vmcnt(8)
  s_barrier
  s_mov_b32 s50, 0
concat_heads__sliding_block__mha_block__prompt_kernel_qld:
  s_cmp_ge_u32 s50, 16
  s_cbranch_scc1 concat_heads__sliding_block__mha_block__prompt_kernel_qtail
  s_cmp_eq_u32 s44, 10
  s_cbranch_scc0 qsw_3
  s_mov_b32 s4, s16
  s_and_b32 s5, s17, 0xffff
  s_mov_b32 s6, 2621440
  s_mov_b32 s7, 0x20000
  s_mov_b32 s8, s18
  s_and_b32 s9, s19, 0xffff
  s_mov_b32 s10, 2457600
  s_mov_b32 s11, 0x20000
  s_mov_b32 s45, s54
qsw_3:
  s_add_u32 s46, s43, s42
  s_mul_i32 s47, s45, 245760
  s_add_u32 s47, s47, s41
  s_lshl_b32 s48, s45, 7
  s_add_u32 s48, s48, s40
  s_add_u32 m0, s46, 16384
  s_add_u32 s49, s47, 0
  buffer_load_dwordx4 v12, s[8:11], s49 offen lds
  s_add_u32 m0, s46, 17408
  s_add_u32 s49, s47, 15360
  buffer_load_dwordx4 v12, s[8:11], s49 offen lds
  s_add_u32 m0, s46, 18432
  s_add_u32 s49, s47, 30720
  buffer_load_dwordx4 v12, s[8:11], s49 offen lds
  s_add_u32 m0, s46, 19456
  s_add_u32 s49, s47, 46080
  buffer_load_dwordx4 v12, s[8:11], s49 offen lds
  s_add_u32 m0, s46, 0
  s_add_u32 s49, s48, 0
  buffer_load_dwordx4 v10, s[4:7], s49 offen lds
  s_add_u32 m0, s46, 1024
  s_add_u32 s49, s48, 10240
  buffer_load_dwordx4 v11, s[4:7], s49 offen lds
  s_add_u32 m0, s46, 2048
  s_add_u32 s49, s48, 20480
  buffer_load_dwordx4 v10, s[4:7], s49 offen lds
  s_add_u32 m0, s46, 3072
  s_add_u32 s49, s48, 30720
  buffer_load_dwordx4 v11, s[4:7], s49 offen lds
  s_add_u32 s45, s45, 1
  s_cmp_eq_u32 s45, 10
  s_cselect_b32 s45, 0, s45
  s_add_u32 s44, s44, 1
  s_add_u32 s43, s43, 32768
  s_and_b32 s43, s43, 131071
  s_waitcnt vmcnt(8)
  s_barrier
  s_add_u32 s50, s50, 1
  s_branch concat_heads__sliding_block__mha_block__prompt_kernel_qld
concat_heads__sliding_block__mha_block__prompt_kernel_qtail:
  s_cmp_eq_u32 s44, 10
  s_cbranch_scc0 qsw_4
  s_mov_b32 s4, s16
  s_and_b32 s5, s17, 0xffff
  s_mov_b32 s6, 2621440
  s_mov_b32 s7, 0x20000
  s_mov_b32 s8, s18
  s_and_b32 s9, s19, 0xffff
  s_mov_b32 s10, 2457600
  s_mov_b32 s11, 0x20000
  s_mov_b32 s45, s54
qsw_4:
  s_add_u32 s46, s43, s42
  s_mul_i32 s47, s45, 245760
  s_add_u32 s47, s47, s41
  s_lshl_b32 s48, s45, 7
  s_add_u32 s48, s48, s40
  s_add_u32 m0, s46, 16384
  s_add_u32 s49, s47, 0
  buffer_load_dwordx4 v12, s[8:11], s49 offen lds
  s_add_u32 m0, s46, 17408
  s_add_u32 s49, s47, 15360
  buffer_load_dwordx4 v12, s[8:11], s49 offen lds
  s_add_u32 m0, s46, 18432
  s_add_u32 s49, s47, 30720
  buffer_load_dwordx4 v12, s[8:11], s49 offen lds
  s_add_u32 m0, s46, 19456
  s_add_u32 s49, s47, 46080
  buffer_load_dwordx4 v12, s[8:11], s49 offen lds
  s_add_u32 m0, s46, 0
  s_add_u32 s49, s48, 0
  buffer_load_dwordx4 v10, s[4:7], s49 offen lds
  s_add_u32 m0, s46, 1024
  s_add_u32 s49, s48, 10240
  buffer_load_dwordx4 v11, s[4:7], s49 offen lds
  s_add_u32 m0, s46, 2048
  s_add_u32 s49, s48, 20480
  buffer_load_dwordx4 v10, s[4:7], s49 offen lds
  s_add_u32 m0, s46, 3072
  s_add_u32 s49, s48, 30720
  buffer_load_dwordx4 v11, s[4:7], s49 offen lds
  s_add_u32 s45, s45, 1
  s_cmp_eq_u32 s45, 10
  s_cselect_b32 s45, 0, s45
  s_add_u32 s44, s44, 1
  s_add_u32 s43, s43, 32768
  s_and_b32 s43, s43, 131071
  s_cmp_eq_u32 s33, 0
  s_cbranch_scc0 concat_heads__sliding_block__mha_block__prompt_kernel_qs1
  v_lshlrev_b32 v20, 7, v1
  v_add_u32 v20, 25167872, v20
  v_mov_b32 v22, 0
  s_mov_b64 exec, 0xffff
  buffer_load_dword v21, v20, s[12:15], 0 offen sc1
  s_mov_b64 exec, -1
  global_load_dword v23, v22, s[30:31] sc0 sc1
  s_waitcnt vmcnt(10)
  s_branch concat_heads__sliding_block__mha_block__prompt_kernel_qs2
concat_heads__sliding_block__mha_block__prompt_kernel_qs1:
  s_waitcnt vmcnt(8)
concat_heads__sliding_block__mha_block__prompt_kernel_qs2:
  s_barrier
  s_cmp_eq_u32 s44, 10
  s_cbranch_scc0 qsw_5
  s_mov_b32 s4, s16
  s_and_b32 s5, s17, 0xffff
  s_mov_b32 s6, 2621440
  s_mov_b32 s7, 0x20000
  s_mov_b32 s8, s18
  s_and_b32 s9, s19, 0xffff
  s_mov_b32 s10, 2457600
  s_mov_b32 s11, 0x20000
  s_mov_b32 s45, s54
qsw_5:
  s_add_u32 s46, s43, s42
  s_mul_i32 s47, s45, 245760
  s_add_u32 s47, s47, s41
  s_lshl_b32 s48, s45, 7
  s_add_u32 s48, s48, s40
  s_add_u32 m0, s46, 16384
  s_add_u32 s49, s47, 0
  buffer_load_dwordx4 v12, s[8:11], s49 offen lds
  s_add_u32 m0, s46, 17408
  s_add_u32 s49, s47, 15360
  buffer_load_dwordx4 v12, s[8:11], s49 offen lds
  s_add_u32 m0, s46, 18432
  s_add_u32 s49, s47, 30720
  buffer_load_dwordx4 v12, s[8:11], s49 offen lds
  s_add_u32 m0, s46, 19456
  s_add_u32 s49, s47, 46080
  buffer_load_dwordx4 v12, s[8:11], s49 offen lds
  s_add_u32 m0, s46, 0
  s_add_u32 s49, s48, 0
  buffer_load_dwordx4 v10, s[4:7], s49 offen lds
  s_add_u32 m0, s46, 1024
  s_add_u32 s49, s48, 10240
  buffer_load_dwordx4 v11, s[4:7], s49 offen lds
  s_add_u32 m0, s46, 2048
  s_add_u32 s49, s48, 20480
  buffer_load_dwordx4 v10, s[4:7], s49 offen lds
  s_add_u32 m0, s46, 3072
  s_add_u32 s49, s48, 30720
  buffer_load_dwordx4 v11, s[4:7], s49 offen lds
  s_add_u32 s45, s45, 1
  s_cmp_eq_u32 s45, 10
  s_cselect_b32 s45, 0, s45
  s_add_u32 s44, s44, 1
  s_add_u32 s43, s43, 32768
  s_and_b32 s43, s43, 131071
  s_and_b32 s34, s2, 7
  s_lshr_b32 s35, s2, 3
  s_lshr_b32 s36, s35, 3
  s_lshl_b32 s34, s34, 2
  s_add_u32 s34, s34, s36
  s_and_b32 s35, s35, 7
  s_mul_i32 s36, s34, 1280
  s_mul_i32 s37, s34, 320
  s_add_u32 s37, s37, 40960
  s_movk_i32 s47, 3121
  v_add_u32 v2, 0, v1
  v_lshlrev_b32 v3, 4, v2
  v_add_u32 v4, s36, v3
  v_add_u32 v6, 39680, v4
  v_subrev_u32 v5, 80, v2
  v_and_b32 v5, 0xff, v5
  v_mul_u32_u24 v7, s47, v5
  v_lshrrev_b32 v7, 16, v7
  v_mul_u32_u24 v8, 21, v7
  v_sub_u32 v8, v5, v8
  v_mul_u32_u24 v7, 10240, v7
  v_lshl_add_u32 v7, v8, 4, v7
  v_add_u32 v7, s37, v7
  v_cmp_gt_u32 vcc, 80, v2
  s_nop 1
  v_cndmask_b32 v10, v7, v4, vcc
  v_cndmask_b32 v13, v6, v4, vcc
  v_add_u32 v2, 64, v1
  v_lshlrev_b32 v3, 4, v2
  v_add_u32 v4, s36, v3
  v_add_u32 v6, 39680, v4
  v_subrev_u32 v5, 80, v2
  v_and_b32 v5, 0xff, v5
  v_mul_u32_u24 v7, s47, v5
  v_lshrrev_b32 v7, 16, v7
  v_mul_u32_u24 v8, 21, v7
  v_sub_u32 v8, v5, v8
  v_mul_u32_u24 v7, 10240, v7
  v_lshl_add_u32 v7, v8, 4, v7
  v_add_u32 v7, s37, v7
  v_cmp_gt_u32 vcc, 80, v2
  s_nop 1
  v_cndmask_b32 v11, v7, v4, vcc
  v_cndmask_b32 v14, v6, v4, vcc
  v_cmp_gt_u32 s[56:57], 20, v8
  s_movk_i32 s55, 164
  v_cmp_gt_u32 s[58:59], s55, v2
  s_nop 1
  s_and_b64 s[56:57], s[56:57], s[58:59]
  s_or_b64 s[38:39], s[56:57], vcc
  v_add_u32 v2, 128, v1
  v_lshlrev_b32 v3, 4, v2
  v_add_u32 v4, s36, v3
  v_add_u32 v6, 39680, v4
  v_subrev_u32 v5, 80, v2
  v_and_b32 v5, 0xff, v5
  v_mul_u32_u24 v7, s47, v5
  v_lshrrev_b32 v7, 16, v7
  v_mul_u32_u24 v8, 21, v7
  v_sub_u32 v8, v5, v8
  v_mul_u32_u24 v7, 10240, v7
  v_lshl_add_u32 v7, v8, 4, v7
  v_add_u32 v7, s37, v7
  v_cmp_gt_u32 vcc, 80, v2
  s_nop 1
  v_cndmask_b32 v12, v7, v4, vcc
  v_cndmask_b32 v15, v6, v4, vcc
  v_cmp_gt_u32 s[56:57], 20, v8
  s_movk_i32 s55, 164
  v_cmp_gt_u32 s[58:59], s55, v2
  s_nop 1
  s_and_b64 s[56:57], s[56:57], s[58:59]
  s_or_b64 s[58:59], s[56:57], vcc
  s_mul_i32 s43, s33, 2624
  v_mov_b32 v20, 25165824
  s_mov_b32 s50, 0
  s_waitcnt vmcnt(8)
  s_cmp_eq_u32 s33, 0
  s_cbranch_scc0 concat_heads__sliding_block__mha_block__prompt_kernel_qs3
  s_mov_b64 exec, 0xffff
  v_cmp_ne_u32 vcc, 15, v21
  s_mov_b64 exec, -1
  v_readfirstlane_b32 s52, v23
  s_cmp_eq_u64 vcc, 0
  s_cbranch_scc0 concat_heads__sliding_block__mha_block__prompt_kernel_qs3
  s_nop 2
  s_cmp_eq_u32 s52, 1
  s_cbranch_scc0 concat_heads__sliding_block__mha_block__prompt_kernel_qs3
  v_mov_b32 v24, 163588
  v_mov_b32 v25, 1
  ds_write_b32 v24, v25
  s_waitcnt lgkmcnt(0)
concat_heads__sliding_block__mha_block__prompt_kernel_qs3:
  s_barrier
  v_mov_b32 v24, 163588
  ds_read_b32 v25, v24
  s_waitcnt lgkmcnt(0)
  v_readfirstlane_b32 s52, v25
  s_nop 3
  s_cmp_eq_u32 s52, 1
  s_cbranch_scc0 concat_heads__sliding_block__mha_block__prompt_kernel_qs4
  s_lshl_b32 s40, s35, 3
  s_lshl_b32 s41, s33, 1
  s_add_u32 s40, s40, s41
  s_add_u32 s40, s40, 64
  s_mul_i32 s40, s40, 40960
  s_mul_i32 s41, s33, 2560
  s_add_u32 m0, s41, 0
  s_nop 0
  buffer_load_dwordx4 v13, s[12:15], s40 offen sc1 lds
  s_add_u32 m0, s41, 1024
  s_nop 0
  buffer_load_dwordx4 v14, s[12:15], s40 offen sc1 lds
  s_add_u32 m0, s41, 2048
  s_mov_b32 exec_hi, 0
  buffer_load_dwordx4 v15, s[12:15], s40 offen sc1 lds
  s_mov_b64 exec, -1
  s_mov_b32 s44, 10240
  s_mov_b32 s46, 0
  s_lshl_b32 s40, s46, 2
  s_add_u32 s40, s40, s33
  s_add_u32 s40, s40, 64
  s_mul_i32 s40, s40, 81920
  s_add_u32 s40, s40, 5242880
  s_add_u32 s41, s44, s43
  s_mov_b32 m0, s41
  s_nop 0
  buffer_load_dwordx4 v10, s[12:15], s40 offen sc1 lds
  s_add_u32 m0, s41, 1024
  s_mov_b64 exec, s[38:39]
  buffer_load_dwordx4 v11, s[12:15], s40 offen sc1 lds
  s_add_u32 m0, s41, 2048
  s_mov_b64 exec, s[58:59]
  buffer_load_dwordx4 v12, s[12:15], s40 offen sc1 lds
  s_mov_b64 exec, -1
  s_add_u32 s45, s40, 2621440
  s_add_u32 s41, s41, 10496
  s_mov_b32 m0, s41
  s_nop 0
  buffer_load_dwordx4 v10, s[12:15], s45 offen sc1 lds
  s_add_u32 m0, s41, 1024
  s_mov_b64 exec, s[38:39]
  buffer_load_dwordx4 v11, s[12:15], s45 offen sc1 lds
  s_add_u32 m0, s41, 2048
  s_mov_b64 exec, s[58:59]
  buffer_load_dwordx4 v12, s[12:15], s45 offen sc1 lds
  s_mov_b64 exec, -1
  s_add_u32 s46, s46, 1
  s_add_u32 s44, s44, 20992
  s_cmp_eq_u32 s44, 73216
  s_cselect_b32 s44, 10240, s44
  s_waitcnt vmcnt(9)
  s_barrier
  s_branch concat_heads__sliding_block__mha_block__prompt_kernel_a_b1
concat_heads__sliding_block__mha_block__prompt_kernel_qs4:
  s_waitcnt vmcnt(0)
  s_barrier
  s_branch concat_heads__sliding_block__mha_block__prompt_kernel_a_late
concat_heads__sliding_block__mha_block__prompt_kernel_a_late:
  v_lshlrev_b32 v20, 7, v1
  v_add_u32 v20, 25167872, v20
  v_mov_b32 v24, 163588
  ds_read_b32 v25, v24
  s_waitcnt lgkmcnt(0)
  v_readfirstlane_b32 s52, v25
  s_nop 3
  s_cmp_eq_u32 s52, 1
  s_cbranch_scc1 concat_heads__sliding_block__mha_block__prompt_kernel_a_go
  v_mov_b32 v24, 163588
  s_cmp_eq_u32 s33, 0
  s_cbranch_scc0 concat_heads__sliding_block__mha_block__prompt_kernel_gB_w
  s_cmp_eq_u32 s62, 0
  s_cbranch_scc0 concat_heads__sliding_block__mha_block__prompt_kernel_pB1
  s_mov_b32 s52, 0
  v_mov_b32 v22, 0
concat_heads__sliding_block__mha_block__prompt_kernel_api0:
  global_load_dword v23, v22, s[30:31] sc0 sc1
  s_waitcnt vmcnt(0)
  v_readfirstlane_b32 s53, v23
  s_add_u32 s52, s52, 1
  s_cmp_eq_u32 s53, 1
  s_cbranch_scc1 concat_heads__sliding_block__mha_block__prompt_kernel_api0_ok
  s_sleep 4
  s_cmp_lt_u32 s52, 0x8000
  s_cbranch_scc1 concat_heads__sliding_block__mha_block__prompt_kernel_api0
concat_heads__sliding_block__mha_block__prompt_kernel_api0_ok:
  s_mov_b32 s52, 0
  s_mov_b64 exec, 0x1
concat_heads__sliding_block__mha_block__prompt_kernel_apB0:
  buffer_load_dword v21, v20, s[12:15], 0 offen sc1
  s_waitcnt vmcnt(0)
  v_cmp_eq_u32 vcc, 0, v21
  s_add_u32 s52, s52, 1
  s_cmp_eq_u64 vcc, 0
  s_cbranch_scc1 concat_heads__sliding_block__mha_block__prompt_kernel_apB0_ok
  s_sleep 30
  s_cmp_lt_u32 s52, 0x8000
  s_cbranch_scc1 concat_heads__sliding_block__mha_block__prompt_kernel_apB0
concat_heads__sliding_block__mha_block__prompt_kernel_apB0_ok:
  s_mov_b64 exec, -1
concat_heads__sliding_block__mha_block__prompt_kernel_pB1:
  s_mov_b32 s52, 0
  s_mov_b64 exec, 0xffff
concat_heads__sliding_block__mha_block__prompt_kernel_apB:
  buffer_load_dword v21, v20, s[12:15], 0 offen sc1
  s_waitcnt vmcnt(0)
  v_cmp_ne_u32 vcc, 15, v21
  s_add_u32 s52, s52, 1
  s_cmp_eq_u64 vcc, 0
  s_cbranch_scc1 concat_heads__sliding_block__mha_block__prompt_kernel_apB_ok
  s_sleep 4
  s_cmp_lt_u32 s52, 0x8000
  s_cbranch_scc1 concat_heads__sliding_block__mha_block__prompt_kernel_apB
concat_heads__sliding_block__mha_block__prompt_kernel_apB_ok:
  s_mov_b64 exec, -1
  v_mov_b32 v25, 1
  ds_write_b32 v24, v25
  s_branch concat_heads__sliding_block__mha_block__prompt_kernel_gB_d
concat_heads__sliding_block__mha_block__prompt_kernel_gB_w:
  s_mov_b32 s52, 0
concat_heads__sliding_block__mha_block__prompt_kernel_gB_l:
  ds_read_b32 v25, v24
  s_waitcnt lgkmcnt(0)
  v_readfirstlane_b32 s53, v25
  s_add_u32 s52, s52, 1
  s_cmp_eq_u32 s53, 1
  s_cbranch_scc1 concat_heads__sliding_block__mha_block__prompt_kernel_gB_d
  s_sleep 1
  s_cmp_lt_u32 s52, 0x100000
  s_cbranch_scc1 concat_heads__sliding_block__mha_block__prompt_kernel_gB_l
concat_heads__sliding_block__mha_block__prompt_kernel_gB_d:
concat_heads__sliding_block__mha_block__prompt_kernel_a_go:
  s_lshl_b32 s40, s35, 3
  s_lshl_b32 s41, s33, 1
  s_add_u32 s40, s40, s41
  s_add_u32 s40, s40, 64
  s_mul_i32 s40, s40, 40960
  s_mul_i32 s41, s33, 2560
  s_add_u32 m0, s41, 0
  s_nop 0
  buffer_load_dwordx4 v13, s[12:15], s40 offen sc1 lds
  s_add_u32 m0, s41, 1024
  s_nop 0
  buffer_load_dwordx4 v14, s[12:15], s40 offen sc1 lds
  s_add_u32 m0, s41, 2048
  s_mov_b32 exec_hi, 0
  buffer_load_dwordx4 v15, s[12:15], s40 offen sc1 lds
  s_mov_b64 exec, -1
concat_heads__sliding_block__mha_block__prompt_kernel_ldround:
  s_mov_b32 s44, 10240
  s_mov_b32 s46, 0
  s_lshl_b32 s40, s46, 2
  s_add_u32 s40, s40, s33
  s_add_u32 s40, s40, 64
  s_mul_i32 s40, s40, 81920
  s_add_u32 s40, s40, 5242880
  s_add_u32 s41, s44, s43
  s_mov_b32 m0, s41
  s_nop 0
  buffer_load_dwordx4 v10, s[12:15], s40 offen sc1 lds
  s_add_u32 m0, s41, 1024
  s_mov_b64 exec, s[38:39]
  buffer_load_dwordx4 v11, s[12:15], s40 offen sc1 lds
  s_add_u32 m0, s41, 2048
  s_mov_b64 exec, s[58:59]
  buffer_load_dwordx4 v12, s[12:15], s40 offen sc1 lds
  s_mov_b64 exec, -1
  s_add_u32 s45, s40, 2621440
  s_add_u32 s41, s41, 10496
  s_mov_b32 m0, s41
  s_nop 0
  buffer_load_dwordx4 v10, s[12:15], s45 offen sc1 lds
  s_add_u32 m0, s41, 1024
  s_mov_b64 exec, s[38:39]
  buffer_load_dwordx4 v11, s[12:15], s45 offen sc1 lds
  s_add_u32 m0, s41, 2048
  s_mov_b64 exec, s[58:59]
  buffer_load_dwordx4 v12, s[12:15], s45 offen sc1 lds
  s_mov_b64 exec, -1
  s_add_u32 s46, s46, 1
  s_add_u32 s44, s44, 20992
  s_cmp_eq_u32 s44, 73216
  s_cselect_b32 s44, 10240, s44
concat_heads__sliding_block__mha_block__prompt_kernel_a_b1:
  s_cmp_eq_u32 s50, 0
  s_cbranch_scc0 concat_heads__sliding_block__mha_block__prompt_kernel_a_b1x
  v_mov_b32 v24, 163608
  v_mov_b32 v25, 1
  s_mov_b64 exec, 1
  ds_add_u32 v24, v25
  s_mov_b64 exec, -1
concat_heads__sliding_block__mha_block__prompt_kernel_a_b1x:
  s_waitcnt vmcnt(0)
  s_barrier
  s_lshl_b32 s40, s46, 2
  s_add_u32 s40, s40, s33
  s_add_u32 s40, s40, 64
  s_mul_i32 s40, s40, 81920
  s_add_u32 s40, s40, 5242880
  s_add_u32 s41, s44, s43
  s_mov_b32 m0, s41
  s_nop 0
  buffer_load_dwordx4 v10, s[12:15], s40 offen sc1 lds
  s_add_u32 m0, s41, 1024
  s_mov_b64 exec, s[38:39]
  buffer_load_dwordx4 v11, s[12:15], s40 offen sc1 lds
  s_add_u32 m0, s41, 2048
  s_mov_b64 exec, s[58:59]
  buffer_load_dwordx4 v12, s[12:15], s40 offen sc1 lds
  s_mov_b64 exec, -1
  s_add_u32 s45, s40, 2621440
  s_add_u32 s41, s41, 10496
  s_mov_b32 m0, s41
  s_nop 0
  buffer_load_dwordx4 v10, s[12:15], s45 offen sc1 lds
  s_add_u32 m0, s41, 1024
  s_mov_b64 exec, s[38:39]
  buffer_load_dwordx4 v11, s[12:15], s45 offen sc1 lds
  s_add_u32 m0, s41, 2048
  s_mov_b64 exec, s[58:59]
  buffer_load_dwordx4 v12, s[12:15], s45 offen sc1 lds
  s_mov_b64 exec, -1
  s_add_u32 s46, s46, 1
  s_add_u32 s44, s44, 20992
  s_cmp_eq_u32 s44, 73216
  s_cselect_b32 s44, 10240, s44
  s_lshl_b32 s40, s46, 2
  s_add_u32 s40, s40, s33
  s_add_u32 s40, s40, 64
  s_mul_i32 s40, s40, 81920
  s_add_u32 s40, s40, 5242880
  s_add_u32 s41, s44, s43
  s_mov_b32 m0, s41
  s_nop 0
  buffer_load_dwordx4 v10, s[12:15], s40 offen sc1 lds
  s_add_u32 m0, s41, 1024
  s_mov_b64 exec, s[38:39]
  buffer_load_dwordx4 v11, s[12:15], s40 offen sc1 lds
  s_add_u32 m0, s41, 2048
  s_mov_b64 exec, s[58:59]
  buffer_load_dwordx4 v12, s[12:15], s40 offen sc1 lds
  s_mov_b64 exec, -1
  s_add_u32 s45, s40, 2621440
  s_add_u32 s41, s41, 10496
  s_mov_b32 m0, s41
  s_nop 0
  buffer_load_dwordx4 v10, s[12:15], s45 offen sc1 lds
  s_add_u32 m0, s41, 1024
  s_mov_b64 exec, s[38:39]
  buffer_load_dwordx4 v11, s[12:15], s45 offen sc1 lds
  s_add_u32 m0, s41, 2048
  s_mov_b64 exec, s[58:59]
  buffer_load_dwordx4 v12, s[12:15], s45 offen sc1 lds
  s_mov_b64 exec, -1
  s_add_u32 s46, s46, 1
  s_add_u32 s44, s44, 20992
  s_cmp_eq_u32 s44, 73216
  s_cselect_b32 s44, 10240, s44
  s_waitcnt vmcnt(6)
  s_barrier
  s_cmp_lg_u32 s50, 0
  s_cbranch_scc1 concat_heads__sliding_block__mha_block__prompt_kernel_ldnoA
  s_cmp_eq_u32 s33, 0
  s_cbranch_scc0 concat_heads__sliding_block__mha_block__prompt_kernel_ldnosig
  s_cmp_eq_u32 s62, 0
  s_cbranch_scc1 concat_heads__sliding_block__mha_block__prompt_kernel_ldnosig
  s_mov_b32 s51, s63
  s_lshl_b32 s51, s51, 7
  s_add_u32 s51, s51, 25165824
  v_mov_b32 v22, 0
  v_mov_b32 v23, 1
  s_mov_b64 exec, 1
  buffer_atomic_add v23, v22, s[12:15], s51 offen sc1
  s_mov_b64 exec, -1
concat_heads__sliding_block__mha_block__prompt_kernel_ldnosig:
concat_heads__sliding_block__mha_block__prompt_kernel_ldnoA:
  s_mov_b32 s42, 1
concat_heads__sliding_block__mha_block__prompt_kernel_ldR:
  s_cmp_eq_u32 s50, 0
  s_cbranch_scc0 concat_heads__sliding_block__mha_block__prompt_kernel_ldRw0
  s_cmp_eq_u32 s42, 5
  s_cbranch_scc1 concat_heads__sliding_block__mha_block__prompt_kernel_ldRw5
  s_cmp_eq_u32 s42, 6
  s_cbranch_scc1 concat_heads__sliding_block__mha_block__prompt_kernel_ldRw6
  s_cmp_eq_u32 s42, 4
  s_cbranch_scc0 concat_heads__sliding_block__mha_block__prompt_kernel_ldRw0
  s_waitcnt vmcnt(0)
concat_heads__sliding_block__mha_block__prompt_kernel_ldRw0:
  s_waitcnt vmcnt(0)
  s_branch concat_heads__sliding_block__mha_block__prompt_kernel_ldRw1
concat_heads__sliding_block__mha_block__prompt_kernel_ldRw5:
  s_waitcnt vmcnt(9)
  s_branch concat_heads__sliding_block__mha_block__prompt_kernel_ldRw1
concat_heads__sliding_block__mha_block__prompt_kernel_ldRw6:
  s_waitcnt vmcnt(7)
concat_heads__sliding_block__mha_block__prompt_kernel_ldRw1:
  s_barrier
  s_cmp_ge_u32 s42, 6
  s_cbranch_scc1 concat_heads__sliding_block__mha_block__prompt_kernel_ldDone
  s_lshl_b32 s40, s46, 2
  s_add_u32 s40, s40, s33
  s_add_u32 s40, s40, 64
  s_mul_i32 s40, s40, 81920
  s_add_u32 s40, s40, 5242880
  s_add_u32 s41, s44, s43
  s_mov_b32 m0, s41
  s_nop 0
  buffer_load_dwordx4 v10, s[12:15], s40 offen sc1 lds
  s_add_u32 m0, s41, 1024
  s_mov_b64 exec, s[38:39]
  buffer_load_dwordx4 v11, s[12:15], s40 offen sc1 lds
  s_add_u32 m0, s41, 2048
  s_mov_b64 exec, s[58:59]
  buffer_load_dwordx4 v12, s[12:15], s40 offen sc1 lds
  s_mov_b64 exec, -1
  s_add_u32 s45, s40, 2621440
  s_add_u32 s41, s41, 10496
  s_mov_b32 m0, s41
  s_nop 0
  buffer_load_dwordx4 v10, s[12:15], s45 offen sc1 lds
  s_add_u32 m0, s41, 1024
  s_mov_b64 exec, s[38:39]
  buffer_load_dwordx4 v11, s[12:15], s45 offen sc1 lds
  s_add_u32 m0, s41, 2048
  s_mov_b64 exec, s[58:59]
  buffer_load_dwordx4 v12, s[12:15], s45 offen sc1 lds
  s_mov_b64 exec, -1
  s_add_u32 s46, s46, 1
  s_add_u32 s44, s44, 20992
  s_cmp_eq_u32 s44, 73216
  s_cselect_b32 s44, 10240, s44
  s_cmp_lg_u32 s50, 0
  s_cbranch_scc1 concat_heads__sliding_block__mha_block__prompt_kernel_ldA_skip
  s_cmp_eq_u32 s42, 3
  s_cbranch_scc0 concat_heads__sliding_block__mha_block__prompt_kernel_ldA4
  s_lshl_b32 s40, s35, 1
  s_sub_i32 s40, s40, 2
  v_add_u32 v20, s40, v1
  v_max_i32 v20, 0, v20
  v_lshlrev_b32 v20, 7, v20
  v_add_u32 v20, 25165824, v20
  s_mov_b64 exec, 0xf
  buffer_load_dword v21, v20, s[12:15], 0 offen sc1
  s_mov_b64 exec, -1
  s_branch concat_heads__sliding_block__mha_block__prompt_kernel_ldA_skip
concat_heads__sliding_block__mha_block__prompt_kernel_ldA4:
  s_cmp_eq_u32 s42, 4
  s_cbranch_scc0 concat_heads__sliding_block__mha_block__prompt_kernel_ldA5
  s_mov_b64 exec, 0xf
  v_cmp_ne_u32 vcc, 15, v21
  s_mov_b64 exec, -1
  s_cmp_eq_u64 vcc, 0
  s_cbranch_scc1 concat_heads__sliding_block__mha_block__prompt_kernel_ldA4ok
  s_mov_b32 s52, 0
  s_mov_b64 exec, 0xf
concat_heads__sliding_block__mha_block__prompt_kernel_apA:
  buffer_load_dword v21, v20, s[12:15], 0 offen sc1
  s_waitcnt vmcnt(0)
  v_cmp_ne_u32 vcc, 15, v21
  s_add_u32 s52, s52, 1
  s_cmp_eq_u64 vcc, 0
  s_cbranch_scc1 concat_heads__sliding_block__mha_block__prompt_kernel_apA_ok
  s_sleep 4
  s_cmp_lt_u32 s52, 0x8000
  s_cbranch_scc1 concat_heads__sliding_block__mha_block__prompt_kernel_apA
concat_heads__sliding_block__mha_block__prompt_kernel_apA_ok:
  s_mov_b64 exec, -1
concat_heads__sliding_block__mha_block__prompt_kernel_ldA4ok:
  s_lshl_b32 s40, s35, 3
  s_lshl_b32 s41, s33, 1
  s_add_u32 s40, s40, s41
  s_add_u32 s40, s40, 0
  s_mul_i32 s40, s40, 40960
  s_mul_i32 s41, s33, 2560
  s_add_u32 m0, s41, 115200
  s_nop 0
  buffer_load_dwordx4 v13, s[12:15], s40 offen sc1 lds
  s_add_u32 m0, s41, 116224
  s_nop 0
  buffer_load_dwordx4 v14, s[12:15], s40 offen sc1 lds
  s_add_u32 m0, s41, 117248
  s_mov_b32 exec_hi, 0
  buffer_load_dwordx4 v15, s[12:15], s40 offen sc1 lds
  s_mov_b64 exec, -1
  s_lshl_b32 s47, s35, 3
  s_lshl_b32 s48, s33, 2
  s_add_u32 s47, s47, s48
  s_sub_i32 s47, s47, 8
  s_max_i32 s47, s47, 0
  s_mul_i32 s60, s47, 81920
  s_add_u32 s60, s60, 5242880
  s_mul_i32 s61, s48, 2624
  s_add_u32 s61, s61, 73216
  s_mov_b32 m0, s61
  s_nop 0
  buffer_load_dwordx4 v10, s[12:15], s60 offen sc1 lds
  s_add_u32 m0, s61, 1024
  s_mov_b64 exec, s[38:39]
  buffer_load_dwordx4 v11, s[12:15], s60 offen sc1 lds
  s_add_u32 m0, s61, 2048
  s_mov_b64 exec, s[58:59]
  buffer_load_dwordx4 v12, s[12:15], s60 offen sc1 lds
  s_mov_b64 exec, -1
  s_add_u32 s60, s60, 81920
  s_add_u32 s61, s61, 2624
  s_mov_b32 m0, s61
  s_nop 0
  buffer_load_dwordx4 v10, s[12:15], s60 offen sc1 lds
  s_add_u32 m0, s61, 1024
  s_mov_b64 exec, s[38:39]
  buffer_load_dwordx4 v11, s[12:15], s60 offen sc1 lds
  s_add_u32 m0, s61, 2048
  s_mov_b64 exec, s[58:59]
  buffer_load_dwordx4 v12, s[12:15], s60 offen sc1 lds
  s_mov_b64 exec, -1
  s_add_u32 s60, s60, 81920
  s_add_u32 s61, s61, 2624
  s_branch concat_heads__sliding_block__mha_block__prompt_kernel_ldA_skip
concat_heads__sliding_block__mha_block__prompt_kernel_ldA5:
  s_cmp_eq_u32 s42, 5
  s_cbranch_scc0 concat_heads__sliding_block__mha_block__prompt_kernel_ldA_skip
  s_mov_b32 m0, s61
  s_nop 0
  buffer_load_dwordx4 v10, s[12:15], s60 offen sc1 lds
  s_add_u32 m0, s61, 1024
  s_mov_b64 exec, s[38:39]
  buffer_load_dwordx4 v11, s[12:15], s60 offen sc1 lds
  s_add_u32 m0, s61, 2048
  s_mov_b64 exec, s[58:59]
  buffer_load_dwordx4 v12, s[12:15], s60 offen sc1 lds
  s_mov_b64 exec, -1
  s_add_u32 s60, s60, 81920
  s_add_u32 s61, s61, 2624
  s_mov_b32 m0, s61
  s_nop 0
  buffer_load_dwordx4 v10, s[12:15], s60 offen sc1 lds
  s_add_u32 m0, s61, 1024
  s_mov_b64 exec, s[38:39]
  buffer_load_dwordx4 v11, s[12:15], s60 offen sc1 lds
  s_add_u32 m0, s61, 2048
  s_mov_b64 exec, s[58:59]
  buffer_load_dwordx4 v12, s[12:15], s60 offen sc1 lds
  s_mov_b64 exec, -1
  s_add_u32 s60, s60, 81920
  s_add_u32 s61, s61, 2624
  s_and_b32 s47, s2, 4
  s_cmp_eq_u32 s47, 0
  s_cselect_b32 s56, s24, s26
  s_cselect_b32 s57, s25, s27
  s_mov_b32 s8, s56
  s_and_b32 s9, s57, 0xffff
  s_mov_b32 s10, 819200
  s_mov_b32 s11, 0x20000
  s_lshr_b32 s47, s2, 3
  s_lshl_b32 s48, s33, 6
  v_add_u32 v20, s48, v1
  v_lshlrev_b32 v20, 5, v20
  v_add_u32 v20, s47, v20
  v_lshlrev_b32 v20, 7, v20
  buffer_load_dword v29, v20, s[8:11], 0 offen
concat_heads__sliding_block__mha_block__prompt_kernel_ldA_skip:
  s_add_u32 s42, s42, 1
  s_branch concat_heads__sliding_block__mha_block__prompt_kernel_ldR
concat_heads__sliding_block__mha_block__prompt_kernel_ldDone:
  s_cmp_eq_u32 s50, 1
  s_cbranch_scc0 concat_heads__sliding_block__mha_block__prompt_kernel_ldnoC0
  s_barrier
concat_heads__sliding_block__mha_block__prompt_kernel_ldnoC0:
  s_waitcnt vmcnt(1)
  s_barrier
  s_cmp_eq_u32 s50, 2
  s_cbranch_scc1 concat_heads__sliding_block__mha_block__prompt_kernel_ldfin
  s_add_u32 s50, s50, 1
  s_cmp_eq_u32 s50, 2
  s_cbranch_scc1 concat_heads__sliding_block__mha_block__prompt_kernel_ldround
  s_barrier
  v_mov_b32 v2, 125440
  ds_read_b32 v3, v2
  s_waitcnt lgkmcnt(0)
  v_readfirstlane_b32 s40, v3
  s_nop 3
  s_cmp_eq_u32 s40, 0
  s_cbranch_scc0 concat_heads__sliding_block__mha_block__prompt_kernel_ldround
  s_branch concat_heads__sliding_block__mha_block__prompt_kernel_ldsig
concat_heads__sliding_block__mha_block__prompt_kernel_ldfin:
  s_barrier
concat_heads__sliding_block__mha_block__prompt_kernel_ldsig:
  s_cmp_lt_u32 s33, 2
  s_cbranch_scc0 concat_heads__sliding_block__mha_block__prompt_kernel_ldnosigO
  s_lshl_b32 s51, s33, 3
  s_add_u32 s51, s51, s35
  s_add_u32 s51, s51, 32
  s_lshl_b32 s51, s51, 7
  s_add_u32 s51, s51, 25165824
  v_mov_b32 v22, 0
  v_mov_b32 v23, 1
  s_mov_b64 exec, 1
  buffer_atomic_add v23, v22, s[12:15], s51 offen sc1
  s_mov_b64 exec, -1
concat_heads__sliding_block__mha_block__prompt_kernel_ldnosigO:
  s_and_b32 s37, s2, 7
  s_lshr_b32 s38, s2, 3
  s_lshr_b32 s34, s37, 2
  s_and_b32 s35, s37, 3
  s_lshl_b32 s35, s35, 3
  s_lshr_b32 s36, s38, 2
  s_add_u32 s35, s35, s36
  s_and_b32 s36, s38, 3
  s_cmp_eq_u32 s34, 0
  s_cselect_b32 s56, s24, s26
  s_cselect_b32 s57, s25, s27
  s_mov_b32 s8, s56
  s_and_b32 s9, s57, 0xffff
  s_mov_b32 s10, 819200
  s_mov_b32 s11, 0x20000
  s_movk_i32 s50, 3277
  v_add_u32 v2, 0, v1
  v_mul_u32_u24 v3, s50, v2
  v_lshrrev_b32 v3, 16, v3
  v_mul_u32_u24 v4, 20, v3
  v_sub_u32 v4, v2, v4
  v_lshlrev_b32 v4, 4, v4
  v_and_b32 v5, 3, v3
  v_bfe_u32 v6, v3, 2, 1
  v_lshrrev_b32 v7, 3, v3
  v_lshl_add_u32 v8, v6, 3, v5
  v_lshl_add_u32 v8, v7, 2, v8
  v_mul_u32_u24 v8, 1280, v8
  v_add_u32 v10, v8, v4
  v_mul_u32_u24 v8, 40, v7
  v_mul_u32_u24 v9, 20, v6
  v_add3_u32 v8, v8, v9, v5
  v_add_u32 v8, 16, v8
  v_mul_u32_u24 v8, 1280, v8
  v_add_u32 v15, v8, v4
  v_add_u32 v2, 64, v1
  v_mul_u32_u24 v3, s50, v2
  v_lshrrev_b32 v3, 16, v3
  v_mul_u32_u24 v4, 20, v3
  v_sub_u32 v4, v2, v4
  v_lshlrev_b32 v4, 4, v4
  v_and_b32 v5, 3, v3
  v_bfe_u32 v6, v3, 2, 1
  v_lshrrev_b32 v7, 3, v3
  v_lshl_add_u32 v8, v6, 3, v5
  v_lshl_add_u32 v8, v7, 2, v8
  v_mul_u32_u24 v8, 1280, v8
  v_add_u32 v11, v8, v4
  v_mul_u32_u24 v8, 40, v7
  v_mul_u32_u24 v9, 20, v6
  v_add3_u32 v8, v8, v9, v5
  v_add_u32 v8, 16, v8
  v_mul_u32_u24 v8, 1280, v8
  v_add_u32 v16, v8, v4
  v_add_u32 v2, 128, v1
  v_mul_u32_u24 v3, s50, v2
  v_lshrrev_b32 v3, 16, v3
  v_mul_u32_u24 v4, 20, v3
  v_sub_u32 v4, v2, v4
  v_lshlrev_b32 v4, 4, v4
  v_and_b32 v5, 3, v3
  v_bfe_u32 v6, v3, 2, 1
  v_lshrrev_b32 v7, 3, v3
  v_lshl_add_u32 v8, v6, 3, v5
  v_lshl_add_u32 v8, v7, 2, v8
  v_mul_u32_u24 v8, 1280, v8
  v_add_u32 v12, v8, v4
  v_mul_u32_u24 v8, 40, v7
  v_mul_u32_u24 v9, 20, v6
  v_add3_u32 v8, v8, v9, v5
  v_add_u32 v8, 16, v8
  v_mul_u32_u24 v8, 1280, v8
  v_add_u32 v17, v8, v4
  v_add_u32 v2, 192, v1
  v_mul_u32_u24 v3, s50, v2
  v_lshrrev_b32 v3, 16, v3
  v_mul_u32_u24 v4, 20, v3
  v_sub_u32 v4, v2, v4
  v_lshlrev_b32 v4, 4, v4
  v_and_b32 v5, 3, v3
  v_bfe_u32 v6, v3, 2, 1
  v_lshrrev_b32 v7, 3, v3
  v_lshl_add_u32 v8, v6, 3, v5
  v_lshl_add_u32 v8, v7, 2, v8
  v_mul_u32_u24 v8, 1280, v8
  v_add_u32 v13, v8, v4
  v_mul_u32_u24 v8, 40, v7
  v_mul_u32_u24 v9, 20, v6
  v_add3_u32 v8, v8, v9, v5
  v_add_u32 v8, 16, v8
  v_mul_u32_u24 v8, 1280, v8
  v_add_u32 v18, v8, v4
  v_add_u32 v2, 256, v1
  v_mul_u32_u24 v3, s50, v2
  v_lshrrev_b32 v3, 16, v3
  v_mul_u32_u24 v4, 20, v3
  v_sub_u32 v4, v2, v4
  v_lshlrev_b32 v4, 4, v4
  v_and_b32 v5, 3, v3
  v_bfe_u32 v6, v3, 2, 1
  v_lshrrev_b32 v7, 3, v3
  v_lshl_add_u32 v8, v6, 3, v5
  v_lshl_add_u32 v8, v7, 2, v8
  v_mul_u32_u24 v8, 1280, v8
  v_add_u32 v14, v8, v4
  v_mul_u32_u24 v8, 40, v7
  v_mul_u32_u24 v9, 20, v6
  v_add3_u32 v8, v8, v9, v5
  v_add_u32 v8, 16, v8
  v_mul_u32_u24 v8, 1280, v8
  v_add_u32 v19, v8, v4
  v_lshlrev_b32 v20, 4, v1
  s_mul_i32 s39, s36, 320
  s_lshl_b32 s40, s34, 6
  s_lshl_b32 s41, s35, 1
  s_add_u32 s40, s40, s41
  s_mul_i32 s40, s40, 40960
  s_add_u32 s40, s40, 16777216
  s_lshl_b32 s41, s33, 10
  s_add_u32 s40, s40, s41
  s_mul_i32 s42, s33, 5120
  s_add_u32 s43, s41, 81920
  s_mov_b32 s44, 0
  s_mov_b32 s45, 0
concat_heads__sliding_block__mha_block__prompt_kernel_opre:
  s_lshl_b32 s46, s44, 2
  s_add_u32 s46, s46, s33
  s_add_u32 s47, s45, s42
  s_cmp_ge_u32 s46, 32
  s_cbranch_scc1 concat_heads__sliding_block__mha_block__prompt_kernel_left_6
  s_mul_i32 s48, s46, 25600
  s_add_u32 s48, s48, s39
  s_add_u32 m0, s47, 0
  s_nop 0
  buffer_load_dwordx4 v10, s[8:11], s48 offen lds
  s_add_u32 m0, s47, 1024
  s_nop 0
  buffer_load_dwordx4 v11, s[8:11], s48 offen lds
  s_add_u32 m0, s47, 2048
  s_nop 0
  buffer_load_dwordx4 v12, s[8:11], s48 offen lds
  s_add_u32 m0, s47, 3072
  s_nop 0
  buffer_load_dwordx4 v13, s[8:11], s48 offen lds
  s_add_u32 m0, s47, 4096
  s_nop 0
  buffer_load_dwordx4 v14, s[8:11], s48 offen lds
  s_branch concat_heads__sliding_block__mha_block__prompt_kernel_wdone_7
concat_heads__sliding_block__mha_block__prompt_kernel_left_6:
  s_sub_u32 s48, s46, 32
  s_mul_i32 s48, s48, 102400
  s_add_u32 s48, s48, s39
  s_add_u32 m0, s47, 0
  s_nop 0
  buffer_load_dwordx4 v15, s[8:11], s48 offen lds
  s_add_u32 m0, s47, 1024
  s_nop 0
  buffer_load_dwordx4 v16, s[8:11], s48 offen lds
  s_add_u32 m0, s47, 2048
  s_nop 0
  buffer_load_dwordx4 v17, s[8:11], s48 offen lds
  s_add_u32 m0, s47, 3072
  s_nop 0
  buffer_load_dwordx4 v18, s[8:11], s48 offen lds
  s_add_u32 m0, s47, 4096
  s_nop 0
  buffer_load_dwordx4 v19, s[8:11], s48 offen lds
concat_heads__sliding_block__mha_block__prompt_kernel_wdone_7:
  s_add_u32 s44, s44, 1
  s_add_u32 s45, s45, 20480
  s_cmp_eq_u32 s45, 81920
  s_cselect_b32 s45, 0, s45
  s_cmp_lt_u32 s44, 4
  s_cbranch_scc1 concat_heads__sliding_block__mha_block__prompt_kernel_opre
  s_cmp_eq_u32 s33, 0
  s_cbranch_scc0 concat_heads__sliding_block__mha_block__prompt_kernel_onp
  s_lshr_b32 s51, s35, 2
  s_lshl_b32 s53, s34, 3
  s_add_u32 s51, s51, s53
  s_add_u32 s51, s51, 32
  s_lshl_b32 s51, s51, 7
  s_add_u32 s51, s51, 25165824
  v_mov_b32 v21, s51
  s_mov_b32 s52, 0
  s_mov_b64 exec, 0x1
concat_heads__sliding_block__mha_block__prompt_kernel_opoll:
  buffer_load_dword v22, v21, s[12:15], 0 offen sc1
  s_waitcnt vmcnt(0)
  v_cmp_ne_u32 vcc, 32, v22
  s_add_u32 s52, s52, 1
  s_cmp_eq_u64 vcc, 0
  s_cbranch_scc1 concat_heads__sliding_block__mha_block__prompt_kernel_opoll_ok
  s_sleep 2
  s_cmp_lt_u32 s52, 0x8000
  s_cbranch_scc1 concat_heads__sliding_block__mha_block__prompt_kernel_opoll
concat_heads__sliding_block__mha_block__prompt_kernel_opoll_ok:
  s_mov_b64 exec, -1
concat_heads__sliding_block__mha_block__prompt_kernel_onp:
  s_barrier
  s_mov_b32 s51, 0
concat_heads__sliding_block__mha_block__prompt_kernel_opre2:
  s_lshl_b32 s48, s51, 12
  s_add_u32 s53, s48, s43
  s_add_u32 s48, s48, s40
  s_mov_b32 m0, s53
  s_nop 0
  buffer_load_dwordx4 v20, s[12:15], s48 offen sc1 lds
  s_add_u32 s48, s48, 40960
  s_add_u32 m0, s53, 40960
  s_nop 0
  buffer_load_dwordx4 v20, s[12:15], s48 offen sc1 lds
  s_add_u32 s51, s51, 1
  s_cmp_lt_u32 s51, 10
  s_cbranch_scc1 concat_heads__sliding_block__mha_block__prompt_kernel_opre2
  s_waitcnt vmcnt(18)
  s_barrier
  s_waitcnt vmcnt(16)
  s_barrier
  s_lshl_b32 s46, s44, 2
  s_add_u32 s46, s46, s33
  s_add_u32 s47, s45, s42
  s_cmp_ge_u32 s46, 32
  s_cbranch_scc1 concat_heads__sliding_block__mha_block__prompt_kernel_left_8
  s_mul_i32 s48, s46, 25600
  s_add_u32 s48, s48, s39
  s_add_u32 m0, s47, 0
  s_nop 0
  buffer_load_dwordx4 v10, s[8:11], s48 offen lds
  s_add_u32 m0, s47, 1024
  s_nop 0
  buffer_load_dwordx4 v11, s[8:11], s48 offen lds
  s_add_u32 m0, s47, 2048
  s_nop 0
  buffer_load_dwordx4 v12, s[8:11], s48 offen lds
  s_add_u32 m0, s47, 3072
  s_nop 0
  buffer_load_dwordx4 v13, s[8:11], s48 offen lds
  s_add_u32 m0, s47, 4096
  s_nop 0
  buffer_load_dwordx4 v14, s[8:11], s48 offen lds
  s_branch concat_heads__sliding_block__mha_block__prompt_kernel_wdone_9
concat_heads__sliding_block__mha_block__prompt_kernel_left_8:
  s_sub_u32 s48, s46, 32
  s_mul_i32 s48, s48, 102400
  s_add_u32 s48, s48, s39
  s_add_u32 m0, s47, 0
  s_nop 0
  buffer_load_dwordx4 v15, s[8:11], s48 offen lds
  s_add_u32 m0, s47, 1024
  s_nop 0
  buffer_load_dwordx4 v16, s[8:11], s48 offen lds
  s_add_u32 m0, s47, 2048
  s_nop 0
  buffer_load_dwordx4 v17, s[8:11], s48 offen lds
  s_add_u32 m0, s47, 3072
  s_nop 0
  buffer_load_dwordx4 v18, s[8:11], s48 offen lds
  s_add_u32 m0, s47, 4096
  s_nop 0
  buffer_load_dwordx4 v19, s[8:11], s48 offen lds
concat_heads__sliding_block__mha_block__prompt_kernel_wdone_9:
  s_add_u32 s44, s44, 1
  s_add_u32 s45, s45, 20480
  s_cmp_eq_u32 s45, 81920
  s_cselect_b32 s45, 0, s45
  s_waitcnt vmcnt(19)
  s_barrier
  s_lshl_b32 s46, s44, 2
  s_add_u32 s46, s46, s33
  s_add_u32 s47, s45, s42
  s_cmp_ge_u32 s46, 32
  s_cbranch_scc1 concat_heads__sliding_block__mha_block__prompt_kernel_left_10
  s_mul_i32 s48, s46, 25600
  s_add_u32 s48, s48, s39
  s_add_u32 m0, s47, 0
  s_nop 0
  buffer_load_dwordx4 v10, s[8:11], s48 offen lds
  s_add_u32 m0, s47, 1024
  s_nop 0
  buffer_load_dwordx4 v11, s[8:11], s48 offen lds
  s_add_u32 m0, s47, 2048
  s_nop 0
  buffer_load_dwordx4 v12, s[8:11], s48 offen lds
  s_add_u32 m0, s47, 3072
  s_nop 0
  buffer_load_dwordx4 v13, s[8:11], s48 offen lds
  s_add_u32 m0, s47, 4096
  s_nop 0
  buffer_load_dwordx4 v14, s[8:11], s48 offen lds
  s_branch concat_heads__sliding_block__mha_block__prompt_kernel_wdone_11
concat_heads__sliding_block__mha_block__prompt_kernel_left_10:
  s_sub_u32 s48, s46, 32
  s_mul_i32 s48, s48, 102400
  s_add_u32 s48, s48, s39
  s_add_u32 m0, s47, 0
  s_nop 0
  buffer_load_dwordx4 v15, s[8:11], s48 offen lds
  s_add_u32 m0, s47, 1024
  s_nop 0
  buffer_load_dwordx4 v16, s[8:11], s48 offen lds
  s_add_u32 m0, s47, 2048
  s_nop 0
  buffer_load_dwordx4 v17, s[8:11], s48 offen lds
  s_add_u32 m0, s47, 3072
  s_nop 0
  buffer_load_dwordx4 v18, s[8:11], s48 offen lds
  s_add_u32 m0, s47, 4096
  s_nop 0
  buffer_load_dwordx4 v19, s[8:11], s48 offen lds
concat_heads__sliding_block__mha_block__prompt_kernel_wdone_11:
  s_add_u32 s44, s44, 1
  s_add_u32 s45, s45, 20480
  s_cmp_eq_u32 s45, 81920
  s_cselect_b32 s45, 0, s45
  s_waitcnt vmcnt(22)
  s_barrier
  s_lshl_b32 s46, s44, 2
  s_add_u32 s46, s46, s33
  s_add_u32 s47, s45, s42
  s_cmp_ge_u32 s46, 32
  s_cbranch_scc1 concat_heads__sliding_block__mha_block__prompt_kernel_left_12
  s_mul_i32 s48, s46, 25600
  s_add_u32 s48, s48, s39
  s_add_u32 m0, s47, 0
  s_nop 0
  buffer_load_dwordx4 v10, s[8:11], s48 offen lds
  s_add_u32 m0, s47, 1024
  s_nop 0
  buffer_load_dwordx4 v11, s[8:11], s48 offen lds
  s_add_u32 m0, s47, 2048
  s_nop 0
  buffer_load_dwordx4 v12, s[8:11], s48 offen lds
  s_add_u32 m0, s47, 3072
  s_nop 0
  buffer_load_dwordx4 v13, s[8:11], s48 offen lds
  s_add_u32 m0, s47, 4096
  s_nop 0
  buffer_load_dwordx4 v14, s[8:11], s48 offen lds
  s_branch concat_heads__sliding_block__mha_block__prompt_kernel_wdone_13
concat_heads__sliding_block__mha_block__prompt_kernel_left_12:
  s_sub_u32 s48, s46, 32
  s_mul_i32 s48, s48, 102400
  s_add_u32 s48, s48, s39
  s_add_u32 m0, s47, 0
  s_nop 0
  buffer_load_dwordx4 v15, s[8:11], s48 offen lds
  s_add_u32 m0, s47, 1024
  s_nop 0
  buffer_load_dwordx4 v16, s[8:11], s48 offen lds
  s_add_u32 m0, s47, 2048
  s_nop 0
  buffer_load_dwordx4 v17, s[8:11], s48 offen lds
  s_add_u32 m0, s47, 3072
  s_nop 0
  buffer_load_dwordx4 v18, s[8:11], s48 offen lds
  s_add_u32 m0, s47, 4096
  s_nop 0
  buffer_load_dwordx4 v19, s[8:11], s48 offen lds
concat_heads__sliding_block__mha_block__prompt_kernel_wdone_13:
  s_add_u32 s44, s44, 1
  s_add_u32 s45, s45, 20480
  s_cmp_eq_u32 s45, 81920
  s_cselect_b32 s45, 0, s45
  s_waitcnt vmcnt(10)
  s_barrier
  s_lshl_b32 s46, s44, 2
  s_add_u32 s46, s46, s33
  s_add_u32 s47, s45, s42
  s_cmp_ge_u32 s46, 32
  s_cbranch_scc1 concat_heads__sliding_block__mha_block__prompt_kernel_left_14
  s_mul_i32 s48, s46, 25600
  s_add_u32 s48, s48, s39
  s_add_u32 m0, s47, 0
  s_nop 0
  buffer_load_dwordx4 v10, s[8:11], s48 offen lds
  s_add_u32 m0, s47, 1024
  s_nop 0
  buffer_load_dwordx4 v11, s[8:11], s48 offen lds
  s_add_u32 m0, s47, 2048
  s_nop 0
  buffer_load_dwordx4 v12, s[8:11], s48 offen lds
  s_add_u32 m0, s47, 3072
  s_nop 0
  buffer_load_dwordx4 v13, s[8:11], s48 offen lds
  s_add_u32 m0, s47, 4096
  s_nop 0
  buffer_load_dwordx4 v14, s[8:11], s48 offen lds
  s_branch concat_heads__sliding_block__mha_block__prompt_kernel_wdone_15
concat_heads__sliding_block__mha_block__prompt_kernel_left_14:
  s_sub_u32 s48, s46, 32
  s_mul_i32 s48, s48, 102400
  s_add_u32 s48, s48, s39
  s_add_u32 m0, s47, 0
  s_nop 0
  buffer_load_dwordx4 v15, s[8:11], s48 offen lds
  s_add_u32 m0, s47, 1024
  s_nop 0
  buffer_load_dwordx4 v16, s[8:11], s48 offen lds
  s_add_u32 m0, s47, 2048
  s_nop 0
  buffer_load_dwordx4 v17, s[8:11], s48 offen lds
  s_add_u32 m0, s47, 3072
  s_nop 0
  buffer_load_dwordx4 v18, s[8:11], s48 offen lds
  s_add_u32 m0, s47, 4096
  s_nop 0
  buffer_load_dwordx4 v19, s[8:11], s48 offen lds
concat_heads__sliding_block__mha_block__prompt_kernel_wdone_15:
  s_add_u32 s44, s44, 1
  s_add_u32 s45, s45, 20480
  s_cmp_eq_u32 s45, 81920
  s_cselect_b32 s45, 0, s45
  s_waitcnt vmcnt(10)
  s_barrier
  s_lshl_b32 s46, s44, 2
  s_add_u32 s46, s46, s33
  s_add_u32 s47, s45, s42
  s_cmp_ge_u32 s46, 32
  s_cbranch_scc1 concat_heads__sliding_block__mha_block__prompt_kernel_left_16
  s_mul_i32 s48, s46, 25600
  s_add_u32 s48, s48, s39
  s_add_u32 m0, s47, 0
  s_nop 0
  buffer_load_dwordx4 v10, s[8:11], s48 offen lds
  s_add_u32 m0, s47, 1024
  s_nop 0
  buffer_load_dwordx4 v11, s[8:11], s48 offen lds
  s_add_u32 m0, s47, 2048
  s_nop 0
  buffer_load_dwordx4 v12, s[8:11], s48 offen lds
  s_add_u32 m0, s47, 3072
  s_nop 0
  buffer_load_dwordx4 v13, s[8:11], s48 offen lds
  s_add_u32 m0, s47, 4096
  s_nop 0
  buffer_load_dwordx4 v14, s[8:11], s48 offen lds
  s_branch concat_heads__sliding_block__mha_block__prompt_kernel_wdone_17
concat_heads__sliding_block__mha_block__prompt_kernel_left_16:
  s_sub_u32 s48, s46, 32
  s_mul_i32 s48, s48, 102400
  s_add_u32 s48, s48, s39
  s_add_u32 m0, s47, 0
  s_nop 0
  buffer_load_dwordx4 v15, s[8:11], s48 offen lds
  s_add_u32 m0, s47, 1024
  s_nop 0
  buffer_load_dwordx4 v16, s[8:11], s48 offen lds
  s_add_u32 m0, s47, 2048
  s_nop 0
  buffer_load_dwordx4 v17, s[8:11], s48 offen lds
  s_add_u32 m0, s47, 3072
  s_nop 0
  buffer_load_dwordx4 v18, s[8:11], s48 offen lds
  s_add_u32 m0, s47, 4096
  s_nop 0
  buffer_load_dwordx4 v19, s[8:11], s48 offen lds
concat_heads__sliding_block__mha_block__prompt_kernel_wdone_17:
  s_add_u32 s44, s44, 1
  s_add_u32 s45, s45, 20480
  s_cmp_eq_u32 s45, 81920
  s_cselect_b32 s45, 0, s45
  s_waitcnt vmcnt(10)
  s_barrier
  s_lshl_b32 s46, s44, 2
  s_add_u32 s46, s46, s33
  s_add_u32 s47, s45, s42
  s_cmp_ge_u32 s46, 32
  s_cbranch_scc1 concat_heads__sliding_block__mha_block__prompt_kernel_left_18
  s_mul_i32 s48, s46, 25600
  s_add_u32 s48, s48, s39
  s_add_u32 m0, s47, 0
  s_nop 0
  buffer_load_dwordx4 v10, s[8:11], s48 offen lds
  s_add_u32 m0, s47, 1024
  s_nop 0
  buffer_load_dwordx4 v11, s[8:11], s48 offen lds
  s_add_u32 m0, s47, 2048
  s_nop 0
  buffer_load_dwordx4 v12, s[8:11], s48 offen lds
  s_add_u32 m0, s47, 3072
  s_nop 0
  buffer_load_dwordx4 v13, s[8:11], s48 offen lds
  s_add_u32 m0, s47, 4096
  s_nop 0
  buffer_load_dwordx4 v14, s[8:11], s48 offen lds
  s_branch concat_heads__sliding_block__mha_block__prompt_kernel_wdone_19
concat_heads__sliding_block__mha_block__prompt_kernel_left_18:
  s_sub_u32 s48, s46, 32
  s_mul_i32 s48, s48, 102400
  s_add_u32 s48, s48, s39
  s_add_u32 m0, s47, 0
  s_nop 0
  buffer_load_dwordx4 v15, s[8:11], s48 offen lds
  s_add_u32 m0, s47, 1024
  s_nop 0
  buffer_load_dwordx4 v16, s[8:11], s48 offen lds
  s_add_u32 m0, s47, 2048
  s_nop 0
  buffer_load_dwordx4 v17, s[8:11], s48 offen lds
  s_add_u32 m0, s47, 3072
  s_nop 0
  buffer_load_dwordx4 v18, s[8:11], s48 offen lds
  s_add_u32 m0, s47, 4096
  s_nop 0
  buffer_load_dwordx4 v19, s[8:11], s48 offen lds
concat_heads__sliding_block__mha_block__prompt_kernel_wdone_19:
  s_add_u32 s44, s44, 1
  s_add_u32 s45, s45, 20480
  s_cmp_eq_u32 s45, 81920
  s_cselect_b32 s45, 0, s45
  s_waitcnt vmcnt(10)
  s_barrier
  s_waitcnt vmcnt(5)
  s_barrier
  s_waitcnt vmcnt(0)
  s_barrier
  s_endpgm
concat_heads__sliding_block__mha_block__prompt_kernel_compute:
  s_waitcnt lgkmcnt(0)
  s_mov_b32 s12, s60
  s_and_b32 s13, s61, 0xffff
  s_mov_b32 s14, 33554432
  s_mov_b32 s15, 0x20000
  s_cmp_eq_u32 s32, 7
  s_cbranch_scc0 concat_heads__sliding_block__mha_block__prompt_kernel_nosync
  v_mov_b32 v2, 163584
  v_mov_b32 v4, 0
  v_mov_b32 v5, 0
  v_mov_b32 v6, 0
  v_mov_b32 v7, 0
  ds_write_b128 v2, v[4:7]
  ds_write_b128 v2, v[4:7] offset:16
  s_waitcnt lgkmcnt(0)
concat_heads__sliding_block__mha_block__prompt_kernel_nosync:
  s_cmp_eq_u32 s2, 0
  s_cbranch_scc0 concat_heads__sliding_block__mha_block__prompt_kernel_noinit
  s_cmp_eq_u32 s32, 7
  s_cbranch_scc0 concat_heads__sliding_block__mha_block__prompt_kernel_noinit
  v_lshlrev_b32 v2, 7, v1
  v_mov_b32 v3, 0
  s_mov_b32 s36, 25165824
  buffer_store_dword v3, v2, s[12:15], s36 offen sc0 sc1
  s_waitcnt vmcnt(0)
  v_mov_b32 v4, 1
  s_mov_b64 exec, 1
  global_store_dword v3, v4, s[30:31] sc0 sc1
  s_mov_b64 exec, -1
concat_heads__sliding_block__mha_block__prompt_kernel_noinit:
  s_cmp_eq_u32 s32, 6
  s_cbranch_scc0 concat_heads__sliding_block__mha_block__prompt_kernel_notlb
  v_lshlrev_b32 v2, 21, v1
  buffer_load_dword v146, v2, s[12:15], 0 offen sc0 sc1
  s_mov_b32 s4, s28
  s_and_b32 s5, s29, 0xffff
  s_mov_b32 s6, 5242880
  s_mov_b32 s7, 0x20000
  buffer_load_dword v146, v2, s[4:7], 0 offen
  s_mov_b32 s4, s16
  s_and_b32 s5, s17, 0xffff
  s_mov_b32 s6, 2621440
  s_mov_b32 s7, 0x20000
  buffer_load_dword v146, v2, s[4:7], 0 offen
  s_mov_b32 s4, s18
  s_and_b32 s5, s19, 0xffff
  s_mov_b32 s6, 2457600
  s_mov_b32 s7, 0x20000
  buffer_load_dword v146, v2, s[4:7], 0 offen
  s_mov_b32 s4, s24
  s_and_b32 s5, s25, 0xffff
  s_mov_b32 s6, 819200
  s_mov_b32 s7, 0x20000
  buffer_load_dword v146, v2, s[4:7], 0 offen
  s_mov_b32 s4, s26
  s_and_b32 s5, s27, 0xffff
  s_mov_b32 s6, 819200
  s_mov_b32 s7, 0x20000
  buffer_load_dword v146, v2, s[4:7], 0 offen
concat_heads__sliding_block__mha_block__prompt_kernel_notlb:
  s_cmp_eq_u32 s62, 0
  s_cbranch_scc0 concat_heads__sliding_block__mha_block__prompt_kernel_c_q
  s_barrier
  s_branch concat_heads__sliding_block__mha_block__prompt_kernel_c_attn
concat_heads__sliding_block__mha_block__prompt_kernel_c_q:
  s_mul_i32 s36, s35, 52
  s_lshr_b32 s36, s36, 8
  s_mul_i32 s39, s36, 5
  s_sub_u32 s37, s35, s39
  s_and_b32 s45, s32, 1
  s_bfe_u32 s46, s32, 0x10001
  s_lshr_b32 s44, s32, 2
  s_cmp_eq_u32 s44, 0
  s_cbranch_scc1 concat_heads__sliding_block__mha_block__prompt_kernel_qsetup
  s_mov_b32 s54, 0x5055050
  s_and_b32 s55, s2, 7
  s_lshl_b32 s55, s55, 2
  s_lshr_b32 s54, s54, s55
  s_and_b32 s54, s54, 15
  s_lshr_b32 s47, s2, 3
  s_cmp_eq_u32 s32, 4
  s_cbranch_scc0 concat_heads__sliding_block__mha_block__prompt_kernel_tW
  s_and_b32 s48, s2, 3
  s_lshl_b32 s48, s48, 9
  s_lshl_b32 s49, s47, 4
  s_add_u32 s48, s48, s49
  v_add_u32 v8, s48, v1
  v_mul_u32_u24 v8, 1280, v8
  s_movk_i32 s48, 128
  s_mov_b32 s50, 0xffff
  s_mov_b32 s56, s20
  s_mov_b32 s57, s21
  s_mov_b32 s58, s16
  s_mov_b32 s59, s17
  s_mov_b32 s49, 2621440
  s_branch concat_heads__sliding_block__mha_block__prompt_kernel_tD
concat_heads__sliding_block__mha_block__prompt_kernel_tW:
  v_lshrrev_b32 v8, 4, v1
  s_lshl_b32 s48, s47, 1
  v_add_u32 v8, s48, v8
  v_mul_u32_u24 v8, 3840, v8
  v_and_b32 v7, 15, v1
  v_lshl_add_u32 v8, v7, 7, v8
  s_bfe_u32 s48, s2, 0x10002
  s_lshl_b32 s48, s48, 11
  v_add_u32 v8, s48, v8
  s_mov_b32 s48, 245760
  s_mov_b32 s50, -1
  s_mov_b32 s56, s22
  s_mov_b32 s57, s23
  s_mov_b32 s58, s18
  s_mov_b32 s59, s19
  s_mov_b32 s49, 2457600
concat_heads__sliding_block__mha_block__prompt_kernel_tD:
  s_mov_b32 s4, s56
  s_and_b32 s5, s57, 0xffff
  s_mov_b32 s6, s49
  s_mov_b32 s7, 0x20000
  s_mov_b32 s51, 1
concat_heads__sliding_block__mha_block__prompt_kernel_touch_sub_skip:
concat_heads__sliding_block__mha_block__prompt_kernel_qsetup:
  v_and_b32 v2, 31, v1
  v_lshrrev_b32 v3, 5, v1
  v_bfe_u32 v4, v1, 1, 3
  v_xor_b32 v4, v4, v3
  s_lshl_b32 s39, s46, 6
  v_add_u32 v5, s39, v2
  v_lshlrev_b32 v5, 7, v5
  v_xor_b32 v6, 0, v4
  v_lshl_add_u32 v13, v6, 4, v5
  v_xor_b32 v6, 2, v4
  v_lshl_add_u32 v14, v6, 4, v5
  v_xor_b32 v6, 4, v4
  v_lshl_add_u32 v15, v6, 4, v5
  v_xor_b32 v6, 6, v4
  v_lshl_add_u32 v16, v6, 4, v5
  v_bfe_u32 v4, v1, 2, 2
  v_lshl_add_u32 v5, v3, 3, v4
  v_lshlrev_b32 v5, 8, v5
  v_bfe_u32 v6, v1, 4, 1
  v_lshl_add_u32 v5, v6, 5, v5
  v_and_b32 v6, 3, v1
  v_lshl_add_u32 v5, v6, 3, v5
  v_add_u32 v5, 16384, v5
  s_lshl_b32 s39, s45, 1
  s_add_u32 s43, s39, 0
  v_xor_b32 v6, s43, v4
  v_lshl_add_u32 v17, v6, 6, v5
  s_add_u32 s43, s39, 1
  v_xor_b32 v6, s43, v4
  v_lshl_add_u32 v18, v6, 6, v5
  v_mov_b32 v48, 0
  v_mov_b32 v49, 0
  v_mov_b32 v50, 0
  v_mov_b32 v51, 0
  v_mov_b32 v52, 0
  v_mov_b32 v53, 0
  v_mov_b32 v54, 0
  v_mov_b32 v55, 0
  v_mov_b32 v56, 0
  v_mov_b32 v57, 0
  v_mov_b32 v58, 0
  v_mov_b32 v59, 0
  v_mov_b32 v60, 0
  v_mov_b32 v61, 0
  v_mov_b32 v62, 0
  v_mov_b32 v63, 0
  v_mov_b32 v64, 0
  v_mov_b32 v65, 0
  v_mov_b32 v66, 0
  v_mov_b32 v67, 0
  v_mov_b32 v68, 0
  v_mov_b32 v69, 0
  v_mov_b32 v70, 0
  v_mov_b32 v71, 0
  v_mov_b32 v72, 0
  v_mov_b32 v73, 0
  v_mov_b32 v74, 0
  v_mov_b32 v75, 0
  v_mov_b32 v76, 0
  v_mov_b32 v77, 0
  v_mov_b32 v78, 0
  v_mov_b32 v79, 0
  v_mov_b32 v80, 0
  v_mov_b32 v81, 0
  v_mov_b32 v82, 0
  v_mov_b32 v83, 0
  v_mov_b32 v84, 0
  v_mov_b32 v85, 0
  v_mov_b32 v86, 0
  v_mov_b32 v87, 0
  v_mov_b32 v88, 0
  v_mov_b32 v89, 0
  v_mov_b32 v90, 0
  v_mov_b32 v91, 0
  v_mov_b32 v92, 0
  v_mov_b32 v93, 0
  v_mov_b32 v94, 0
  v_mov_b32 v95, 0
  v_mov_b32 v96, 0
  v_mov_b32 v97, 0
  v_mov_b32 v98, 0
  v_mov_b32 v99, 0
  v_mov_b32 v100, 0
  v_mov_b32 v101, 0
  v_mov_b32 v102, 0
  v_mov_b32 v103, 0
  v_mov_b32 v104, 0
  v_mov_b32 v105, 0
  v_mov_b32 v106, 0
  v_mov_b32 v107, 0
  v_mov_b32 v108, 0
  v_mov_b32 v109, 0
  v_mov_b32 v110, 0
  v_mov_b32 v111, 0
  v_mov_b32 v112, 0
  v_mov_b32 v113, 0
  v_mov_b32 v114, 0
  v_mov_b32 v115, 0
  v_mov_b32 v116, 0
  v_mov_b32 v117, 0
  v_mov_b32 v118, 0
  v_mov_b32 v119, 0
  v_mov_b32 v120, 0
  v_mov_b32 v121, 0
  v_mov_b32 v122, 0
  v_mov_b32 v123, 0
  v_mov_b32 v124, 0
  v_mov_b32 v125, 0
  v_mov_b32 v126, 0
  v_mov_b32 v127, 0
  s_xor_b32 s42, s44, 1
  s_mov_b32 s40, 0
  s_mov_b32 s41, 0
  s_cmp_eq_u32 s44, 0
  s_cbranch_scc1 concat_heads__sliding_block__mha_block__prompt_kernel_qgo
concat_heads__sliding_block__mha_block__prompt_kernel_qidle:
  s_barrier
  s_cmp_eq_u32 s32, 7
  s_cbranch_scc0 concat_heads__sliding_block__mha_block__prompt_kernel_qi7
  s_cmp_eq_u32 s41, 5
  s_cbranch_scc0 concat_heads__sliding_block__mha_block__prompt_kernel_qi6
  v_mov_b32 v10, 0
  global_load_dword v11, v10, s[30:31] sc0 sc1
concat_heads__sliding_block__mha_block__prompt_kernel_qi6:
  s_cmp_eq_u32 s41, 9
  s_cbranch_scc0 concat_heads__sliding_block__mha_block__prompt_kernel_qi7
  s_waitcnt vmcnt(0)
  v_readfirstlane_b32 s52, v11
  s_nop 3
  s_cmp_eq_u32 s52, 1
  s_cbranch_scc1 concat_heads__sliding_block__mha_block__prompt_kernel_qi7
  s_mov_b32 s52, 0
  v_mov_b32 v10, 0
concat_heads__sliding_block__mha_block__prompt_kernel_qpi7:
  global_load_dword v11, v10, s[30:31] sc0 sc1
  s_waitcnt vmcnt(0)
  v_readfirstlane_b32 s53, v11
  s_add_u32 s52, s52, 1
  s_cmp_eq_u32 s53, 1
  s_cbranch_scc1 concat_heads__sliding_block__mha_block__prompt_kernel_qpi7_ok
  s_sleep 4
  s_cmp_lt_u32 s52, 0x8000
  s_cbranch_scc1 concat_heads__sliding_block__mha_block__prompt_kernel_qpi7
concat_heads__sliding_block__mha_block__prompt_kernel_qpi7_ok:
concat_heads__sliding_block__mha_block__prompt_kernel_qi7:
  s_add_u32 s41, s41, 1
  s_cmp_lt_u32 s41, 10
  s_cbranch_scc1 concat_heads__sliding_block__mha_block__prompt_kernel_qidle
  s_mov_b32 s40, 65536
concat_heads__sliding_block__mha_block__prompt_kernel_qgo:
  s_add_u32 s47, s41, 10
  s_cmp_eq_u32 s36, 2
  s_cbranch_scc1 concat_heads__sliding_block__mha_block__prompt_kernel_qV
.p2align 6
concat_heads__sliding_block__mha_block__prompt_kernel_qK_loop:
  v_add_u32 v19, s40, v13
  v_add_u32 v20, s40, v14
  v_add_u32 v21, s40, v15
  v_add_u32 v22, s40, v16
  v_add_u32 v23, s40, v17
  v_add_u32 v24, s40, v18
  s_barrier
  ds_read_b64_tr_b16 v[32:33], v23 offset:0
  ds_read_b64_tr_b16 v[34:35], v23 offset:1024
  ds_read_b64_tr_b16 v[36:37], v24 offset:0
  ds_read_b64_tr_b16 v[38:39], v24 offset:1024
  ds_read_b128 v[40:43], v19 offset:0
  ds_read_b128 v[44:47], v19 offset:4096
  v_mfma_f32_32x32x16_bf16 v[64:79], v[48:51], v[56:59], v[64:79]
  v_mfma_f32_32x32x16_bf16 v[80:95], v[48:51], v[60:63], v[80:95]
  v_mfma_f32_32x32x16_bf16 v[96:111], v[52:55], v[56:59], v[96:111]
  v_mfma_f32_32x32x16_bf16 v[112:127], v[52:55], v[60:63], v[112:127]
  ds_read_b64_tr_b16 v[48:49], v23 offset:4096
  ds_read_b64_tr_b16 v[50:51], v23 offset:5120
  ds_read_b64_tr_b16 v[52:53], v24 offset:4096
  ds_read_b64_tr_b16 v[54:55], v24 offset:5120
  ds_read_b128 v[56:59], v20 offset:0
  ds_read_b128 v[60:63], v20 offset:4096
  s_waitcnt lgkmcnt(6)
  v_mfma_f32_32x32x16_bf16 v[64:79], v[32:35], v[40:43], v[64:79]
  v_mfma_f32_32x32x16_bf16 v[80:95], v[32:35], v[44:47], v[80:95]
  v_mfma_f32_32x32x16_bf16 v[96:111], v[36:39], v[40:43], v[96:111]
  v_mfma_f32_32x32x16_bf16 v[112:127], v[36:39], v[44:47], v[112:127]
  ds_read_b64_tr_b16 v[32:33], v23 offset:8192
  ds_read_b64_tr_b16 v[34:35], v23 offset:9216
  ds_read_b64_tr_b16 v[36:37], v24 offset:8192
  ds_read_b64_tr_b16 v[38:39], v24 offset:9216
  ds_read_b128 v[40:43], v21 offset:0
  ds_read_b128 v[44:47], v21 offset:4096
  s_waitcnt lgkmcnt(6)
  v_mfma_f32_32x32x16_bf16 v[64:79], v[48:51], v[56:59], v[64:79]
  v_mfma_f32_32x32x16_bf16 v[80:95], v[48:51], v[60:63], v[80:95]
  v_mfma_f32_32x32x16_bf16 v[96:111], v[52:55], v[56:59], v[96:111]
  v_mfma_f32_32x32x16_bf16 v[112:127], v[52:55], v[60:63], v[112:127]
  ds_read_b64_tr_b16 v[48:49], v23 offset:12288
  ds_read_b64_tr_b16 v[50:51], v23 offset:13312
  ds_read_b64_tr_b16 v[52:53], v24 offset:12288
  ds_read_b64_tr_b16 v[54:55], v24 offset:13312
  ds_read_b128 v[56:59], v22 offset:0
  ds_read_b128 v[60:63], v22 offset:4096
  s_waitcnt lgkmcnt(6)
  v_mfma_f32_32x32x16_bf16 v[64:79], v[32:35], v[40:43], v[64:79]
  v_mfma_f32_32x32x16_bf16 v[80:95], v[32:35], v[44:47], v[80:95]
  v_mfma_f32_32x32x16_bf16 v[96:111], v[36:39], v[40:43], v[96:111]
  v_mfma_f32_32x32x16_bf16 v[112:127], v[36:39], v[44:47], v[112:127]
  s_add_u32 s40, s40, 32768
  s_and_b32 s40, s40, 131071
  s_add_u32 s41, s41, 1
  s_cmp_lt_u32 s41, s47
  s_waitcnt lgkmcnt(0)
  s_cbranch_scc1 concat_heads__sliding_block__mha_block__prompt_kernel_qK_loop
  v_mfma_f32_32x32x16_bf16 v[64:79], v[48:51], v[56:59], v[64:79]
  v_mfma_f32_32x32x16_bf16 v[80:95], v[48:51], v[60:63], v[80:95]
  v_mfma_f32_32x32x16_bf16 v[96:111], v[52:55], v[56:59], v[96:111]
  v_mfma_f32_32x32x16_bf16 v[112:127], v[52:55], v[60:63], v[112:127]
  s_cmp_eq_u32 s44, 0
  s_cbranch_scc0 cb_20
  s_barrier
cb_20:
  s_mov_b32 s48, 0x3ea52b5c
  s_cmp_eq_u32 s36, 0
  s_cselect_b32 s48, s48, 1.0
  s_mov_b32 s49, s48
  s_mov_b32 s50, 81920
  s_cselect_b32 s50, 40960, s50
  s_cselect_b32 s51, 0, 5242880
  s_lshl_b32 s39, s42, 6
  s_lshl_b32 s43, s34, 2
  s_add_u32 s39, s39, s43
  s_lshl_b32 s43, s46, 1
  s_add_u32 s39, s39, s43
  s_mul_i32 s39, s39, s50
  s_add_u32 s51, s51, s39
  s_lshl_b32 s39, s37, 13
  s_add_u32 s51, s51, s39
  s_lshl_b32 s39, s45, 12
  s_add_u32 s51, s51, s39
  s_add_u32 s52, s51, s50
  v_lshrrev_b32 v3, 5, v1
  v_lshlrev_b32 v3, 8, v3
  v_and_b32 v2, 31, v1
  v_lshl_add_u32 v2, v2, 3, v3
  v_lshlrev_b32 v26, 4, v1
  s_cmp_eq_u32 s44, 0
  s_cbranch_scc1 concat_heads__sliding_block__mha_block__prompt_kernel_qe0
  s_and_b32 s39, s32, 3
  s_lshl_b32 s39, s39, 13
  s_add_u32 s39, s39, 32768
  v_add_u32 v25, s39, v2
  v_add_u32 v27, s39, v26
  v_pk_mul_f32 v[64:65], v[64:65], s[48:49]
  v_pk_mul_f32 v[66:67], v[66:67], s[48:49]
  v_cvt_pk_bf16_f32 v64, v64, v65
  v_cvt_pk_bf16_f32 v65, v66, v67
  ds_write_b64 v25, v[64:65] offset:0
  v_pk_mul_f32 v[68:69], v[68:69], s[48:49]
  v_pk_mul_f32 v[70:71], v[70:71], s[48:49]
  v_cvt_pk_bf16_f32 v68, v68, v69
  v_cvt_pk_bf16_f32 v69, v70, v71
  ds_write_b64 v25, v[68:69] offset:512
  v_pk_mul_f32 v[72:73], v[72:73], s[48:49]
  v_pk_mul_f32 v[74:75], v[74:75], s[48:49]
  v_cvt_pk_bf16_f32 v72, v72, v73
  v_cvt_pk_bf16_f32 v73, v74, v75
  ds_write_b64 v25, v[72:73] offset:1024
  v_pk_mul_f32 v[76:77], v[76:77], s[48:49]
  v_pk_mul_f32 v[78:79], v[78:79], s[48:49]
  v_cvt_pk_bf16_f32 v76, v76, v77
  v_cvt_pk_bf16_f32 v77, v78, v79
  ds_write_b64 v25, v[76:77] offset:1536
  v_pk_mul_f32 v[96:97], v[96:97], s[48:49]
  v_pk_mul_f32 v[98:99], v[98:99], s[48:49]
  v_cvt_pk_bf16_f32 v96, v96, v97
  v_cvt_pk_bf16_f32 v97, v98, v99
  ds_write_b64 v25, v[96:97] offset:2048
  v_pk_mul_f32 v[100:101], v[100:101], s[48:49]
  v_pk_mul_f32 v[102:103], v[102:103], s[48:49]
  v_cvt_pk_bf16_f32 v100, v100, v101
  v_cvt_pk_bf16_f32 v101, v102, v103
  ds_write_b64 v25, v[100:101] offset:2560
  v_pk_mul_f32 v[104:105], v[104:105], s[48:49]
  v_pk_mul_f32 v[106:107], v[106:107], s[48:49]
  v_cvt_pk_bf16_f32 v104, v104, v105
  v_cvt_pk_bf16_f32 v105, v106, v107
  ds_write_b64 v25, v[104:105] offset:3072
  v_pk_mul_f32 v[108:109], v[108:109], s[48:49]
  v_pk_mul_f32 v[110:111], v[110:111], s[48:49]
  v_cvt_pk_bf16_f32 v108, v108, v109
  v_cvt_pk_bf16_f32 v109, v110, v111
  ds_write_b64 v25, v[108:109] offset:3584
  v_pk_mul_f32 v[80:81], v[80:81], s[48:49]
  v_pk_mul_f32 v[82:83], v[82:83], s[48:49]
  v_cvt_pk_bf16_f32 v80, v80, v81
  v_cvt_pk_bf16_f32 v81, v82, v83
  ds_write_b64 v25, v[80:81] offset:4096
  v_pk_mul_f32 v[84:85], v[84:85], s[48:49]
  v_pk_mul_f32 v[86:87], v[86:87], s[48:49]
  v_cvt_pk_bf16_f32 v84, v84, v85
  v_cvt_pk_bf16_f32 v85, v86, v87
  ds_write_b64 v25, v[84:85] offset:4608
  v_pk_mul_f32 v[88:89], v[88:89], s[48:49]
  v_pk_mul_f32 v[90:91], v[90:91], s[48:49]
  v_cvt_pk_bf16_f32 v88, v88, v89
  v_cvt_pk_bf16_f32 v89, v90, v91
  ds_write_b64 v25, v[88:89] offset:5120
  v_pk_mul_f32 v[92:93], v[92:93], s[48:49]
  v_pk_mul_f32 v[94:95], v[94:95], s[48:49]
  v_cvt_pk_bf16_f32 v92, v92, v93
  v_cvt_pk_bf16_f32 v93, v94, v95
  ds_write_b64 v25, v[92:93] offset:5632
  v_pk_mul_f32 v[112:113], v[112:113], s[48:49]
  v_pk_mul_f32 v[114:115], v[114:115], s[48:49]
  v_cvt_pk_bf16_f32 v112, v112, v113
  v_cvt_pk_bf16_f32 v113, v114, v115
  ds_write_b64 v25, v[112:113] offset:6144
  v_pk_mul_f32 v[116:117], v[116:117], s[48:49]
  v_pk_mul_f32 v[118:119], v[118:119], s[48:49]
  v_cvt_pk_bf16_f32 v116, v116, v117
  v_cvt_pk_bf16_f32 v117, v118, v119
  ds_write_b64 v25, v[116:117] offset:6656
  v_pk_mul_f32 v[120:121], v[120:121], s[48:49]
  v_pk_mul_f32 v[122:123], v[122:123], s[48:49]
  v_cvt_pk_bf16_f32 v120, v120, v121
  v_cvt_pk_bf16_f32 v121, v122, v123
  ds_write_b64 v25, v[120:121] offset:7168
  v_pk_mul_f32 v[124:125], v[124:125], s[48:49]
  v_pk_mul_f32 v[126:127], v[126:127], s[48:49]
  v_cvt_pk_bf16_f32 v124, v124, v125
  v_cvt_pk_bf16_f32 v125, v126, v127
  ds_write_b64 v25, v[124:125] offset:7680
  s_waitcnt lgkmcnt(8)
  ds_read_b128 v[32:35], v27 offset:0
  ds_read_b128 v[36:39], v27 offset:1024
  ds_read_b128 v[40:43], v27 offset:2048
  ds_read_b128 v[44:47], v27 offset:3072
  s_waitcnt lgkmcnt(4)
  ds_read_b128 v[48:51], v27 offset:4096
  ds_read_b128 v[52:55], v27 offset:5120
  ds_read_b128 v[56:59], v27 offset:6144
  ds_read_b128 v[60:63], v27 offset:7168
  s_waitcnt lgkmcnt(0)
  v_mov_b32 v10, 163608
  s_mov_b32 s53, 0
concat_heads__sliding_block__mha_block__prompt_kernel_h1:
  ds_read_b32 v11, v10
  s_waitcnt lgkmcnt(0)
  v_readfirstlane_b32 s39, v11
  s_add_u32 s53, s53, 1
  s_cmp_ge_u32 s39, 4
  s_cbranch_scc1 concat_heads__sliding_block__mha_block__prompt_kernel_h1_ok
  s_sleep 1
  s_cmp_lt_u32 s53, 0x100000
  s_cbranch_scc1 concat_heads__sliding_block__mha_block__prompt_kernel_h1
concat_heads__sliding_block__mha_block__prompt_kernel_h1_ok:
  s_waitcnt lgkmcnt(7)
  buffer_store_dwordx4 v[32:35], v26, s[12:15], s51 offen offset:0 sc1
  s_waitcnt lgkmcnt(6)
  buffer_store_dwordx4 v[36:39], v26, s[12:15], s51 offen offset:1024 sc1
  s_waitcnt lgkmcnt(5)
  buffer_store_dwordx4 v[40:43], v26, s[12:15], s51 offen offset:2048 sc1
  s_waitcnt lgkmcnt(4)
  buffer_store_dwordx4 v[44:47], v26, s[12:15], s51 offen offset:3072 sc1
  s_waitcnt lgkmcnt(3)
  buffer_store_dwordx4 v[48:51], v26, s[12:15], s52 offen offset:0 sc1
  s_waitcnt lgkmcnt(2)
  buffer_store_dwordx4 v[52:55], v26, s[12:15], s52 offen offset:1024 sc1
  s_waitcnt lgkmcnt(1)
  buffer_store_dwordx4 v[56:59], v26, s[12:15], s52 offen offset:2048 sc1
  s_waitcnt lgkmcnt(0)
  buffer_store_dwordx4 v[60:63], v26, s[12:15], s52 offen offset:3072 sc1
  s_branch concat_heads__sliding_block__mha_block__prompt_kernel_qdone
concat_heads__sliding_block__mha_block__prompt_kernel_qe0:
  s_and_b32 s39, s32, 3
  s_lshl_b32 s39, s39, 12
  s_add_u32 s39, s39, 131072
  v_add_u32 v25, s39, v2
  v_add_u32 v27, s39, v26
  v_pk_mul_f32 v[64:65], v[64:65], s[48:49]
  v_pk_mul_f32 v[66:67], v[66:67], s[48:49]
  v_cvt_pk_bf16_f32 v64, v64, v65
  v_cvt_pk_bf16_f32 v65, v66, v67
  ds_write_b64 v25, v[64:65] offset:0
  v_pk_mul_f32 v[68:69], v[68:69], s[48:49]
  v_pk_mul_f32 v[70:71], v[70:71], s[48:49]
  v_cvt_pk_bf16_f32 v68, v68, v69
  v_cvt_pk_bf16_f32 v69, v70, v71
  ds_write_b64 v25, v[68:69] offset:512
  v_pk_mul_f32 v[72:73], v[72:73], s[48:49]
  v_pk_mul_f32 v[74:75], v[74:75], s[48:49]
  v_cvt_pk_bf16_f32 v72, v72, v73
  v_cvt_pk_bf16_f32 v73, v74, v75
  ds_write_b64 v25, v[72:73] offset:1024
  v_pk_mul_f32 v[76:77], v[76:77], s[48:49]
  v_pk_mul_f32 v[78:79], v[78:79], s[48:49]
  v_cvt_pk_bf16_f32 v76, v76, v77
  v_cvt_pk_bf16_f32 v77, v78, v79
  ds_write_b64 v25, v[76:77] offset:1536
  v_pk_mul_f32 v[96:97], v[96:97], s[48:49]
  v_pk_mul_f32 v[98:99], v[98:99], s[48:49]
  v_cvt_pk_bf16_f32 v96, v96, v97
  v_cvt_pk_bf16_f32 v97, v98, v99
  ds_write_b64 v25, v[96:97] offset:2048
  v_pk_mul_f32 v[100:101], v[100:101], s[48:49]
  v_pk_mul_f32 v[102:103], v[102:103], s[48:49]
  v_cvt_pk_bf16_f32 v100, v100, v101
  v_cvt_pk_bf16_f32 v101, v102, v103
  ds_write_b64 v25, v[100:101] offset:2560
  v_pk_mul_f32 v[104:105], v[104:105], s[48:49]
  v_pk_mul_f32 v[106:107], v[106:107], s[48:49]
  v_cvt_pk_bf16_f32 v104, v104, v105
  v_cvt_pk_bf16_f32 v105, v106, v107
  ds_write_b64 v25, v[104:105] offset:3072
  v_pk_mul_f32 v[108:109], v[108:109], s[48:49]
  v_pk_mul_f32 v[110:111], v[110:111], s[48:49]
  v_cvt_pk_bf16_f32 v108, v108, v109
  v_cvt_pk_bf16_f32 v109, v110, v111
  ds_write_b64 v25, v[108:109] offset:3584
  s_waitcnt lgkmcnt(0)
  ds_read_b128 v[32:35], v27 offset:0
  ds_read_b128 v[36:39], v27 offset:1024
  ds_read_b128 v[40:43], v27 offset:2048
  ds_read_b128 v[44:47], v27 offset:3072
  s_waitcnt lgkmcnt(0)
  buffer_store_dwordx4 v[32:35], v26, s[12:15], s51 offen offset:0 sc1
  buffer_store_dwordx4 v[36:39], v26, s[12:15], s51 offen offset:1024 sc1
  buffer_store_dwordx4 v[40:43], v26, s[12:15], s51 offen offset:2048 sc1
  buffer_store_dwordx4 v[44:47], v26, s[12:15], s51 offen offset:3072 sc1
  v_pk_mul_f32 v[80:81], v[80:81], s[48:49]
  v_pk_mul_f32 v[82:83], v[82:83], s[48:49]
  v_cvt_pk_bf16_f32 v80, v80, v81
  v_cvt_pk_bf16_f32 v81, v82, v83
  ds_write_b64 v25, v[80:81] offset:0
  v_pk_mul_f32 v[84:85], v[84:85], s[48:49]
  v_pk_mul_f32 v[86:87], v[86:87], s[48:49]
  v_cvt_pk_bf16_f32 v84, v84, v85
  v_cvt_pk_bf16_f32 v85, v86, v87
  ds_write_b64 v25, v[84:85] offset:512
  v_pk_mul_f32 v[88:89], v[88:89], s[48:49]
  v_pk_mul_f32 v[90:91], v[90:91], s[48:49]
  v_cvt_pk_bf16_f32 v88, v88, v89
  v_cvt_pk_bf16_f32 v89, v90, v91
  ds_write_b64 v25, v[88:89] offset:1024
  v_pk_mul_f32 v[92:93], v[92:93], s[48:49]
  v_pk_mul_f32 v[94:95], v[94:95], s[48:49]
  v_cvt_pk_bf16_f32 v92, v92, v93
  v_cvt_pk_bf16_f32 v93, v94, v95
  ds_write_b64 v25, v[92:93] offset:1536
  v_pk_mul_f32 v[112:113], v[112:113], s[48:49]
  v_pk_mul_f32 v[114:115], v[114:115], s[48:49]
  v_cvt_pk_bf16_f32 v112, v112, v113
  v_cvt_pk_bf16_f32 v113, v114, v115
  ds_write_b64 v25, v[112:113] offset:2048
  v_pk_mul_f32 v[116:117], v[116:117], s[48:49]
  v_pk_mul_f32 v[118:119], v[118:119], s[48:49]
  v_cvt_pk_bf16_f32 v116, v116, v117
  v_cvt_pk_bf16_f32 v117, v118, v119
  ds_write_b64 v25, v[116:117] offset:2560
  v_pk_mul_f32 v[120:121], v[120:121], s[48:49]
  v_pk_mul_f32 v[122:123], v[122:123], s[48:49]
  v_cvt_pk_bf16_f32 v120, v120, v121
  v_cvt_pk_bf16_f32 v121, v122, v123
  ds_write_b64 v25, v[120:121] offset:3072
  v_pk_mul_f32 v[124:125], v[124:125], s[48:49]
  v_pk_mul_f32 v[126:127], v[126:127], s[48:49]
  v_cvt_pk_bf16_f32 v124, v124, v125
  v_cvt_pk_bf16_f32 v125, v126, v127
  ds_write_b64 v25, v[124:125] offset:3584
  s_waitcnt lgkmcnt(0)
  ds_read_b128 v[48:51], v27 offset:0
  ds_read_b128 v[52:55], v27 offset:1024
  ds_read_b128 v[56:59], v27 offset:2048
  ds_read_b128 v[60:63], v27 offset:3072
  s_waitcnt lgkmcnt(0)
  buffer_store_dwordx4 v[48:51], v26, s[12:15], s52 offen offset:0 sc1
  buffer_store_dwordx4 v[52:55], v26, s[12:15], s52 offen offset:1024 sc1
  buffer_store_dwordx4 v[56:59], v26, s[12:15], s52 offen offset:2048 sc1
  buffer_store_dwordx4 v[60:63], v26, s[12:15], s52 offen offset:3072 sc1
  s_cmp_eq_u32 s44, 0
  s_cbranch_scc0 cb_21
  s_barrier
cb_21:
  s_cmp_eq_u32 s44, 0
  s_cbranch_scc0 cb_22
  s_barrier
cb_22:
  s_branch concat_heads__sliding_block__mha_block__prompt_kernel_qnext
concat_heads__sliding_block__mha_block__prompt_kernel_qV:
.p2align 6
concat_heads__sliding_block__mha_block__prompt_kernel_qV_loop:
  v_add_u32 v19, s40, v13
  v_add_u32 v20, s40, v14
  v_add_u32 v21, s40, v15
  v_add_u32 v22, s40, v16
  v_add_u32 v23, s40, v17
  v_add_u32 v24, s40, v18
  s_barrier
  ds_read_b64_tr_b16 v[32:33], v23 offset:0
  ds_read_b64_tr_b16 v[34:35], v23 offset:1024
  ds_read_b64_tr_b16 v[36:37], v24 offset:0
  ds_read_b64_tr_b16 v[38:39], v24 offset:1024
  ds_read_b128 v[40:43], v19 offset:0
  ds_read_b128 v[44:47], v19 offset:4096
  v_mfma_f32_32x32x16_bf16 v[64:79], v[56:59], v[48:51], v[64:79]
  v_mfma_f32_32x32x16_bf16 v[80:95], v[60:63], v[48:51], v[80:95]
  v_mfma_f32_32x32x16_bf16 v[96:111], v[56:59], v[52:55], v[96:111]
  v_mfma_f32_32x32x16_bf16 v[112:127], v[60:63], v[52:55], v[112:127]
  ds_read_b64_tr_b16 v[48:49], v23 offset:4096
  ds_read_b64_tr_b16 v[50:51], v23 offset:5120
  ds_read_b64_tr_b16 v[52:53], v24 offset:4096
  ds_read_b64_tr_b16 v[54:55], v24 offset:5120
  ds_read_b128 v[56:59], v20 offset:0
  ds_read_b128 v[60:63], v20 offset:4096
  s_waitcnt lgkmcnt(6)
  v_mfma_f32_32x32x16_bf16 v[64:79], v[40:43], v[32:35], v[64:79]
  v_mfma_f32_32x32x16_bf16 v[80:95], v[44:47], v[32:35], v[80:95]
  v_mfma_f32_32x32x16_bf16 v[96:111], v[40:43], v[36:39], v[96:111]
  v_mfma_f32_32x32x16_bf16 v[112:127], v[44:47], v[36:39], v[112:127]
  ds_read_b64_tr_b16 v[32:33], v23 offset:8192
  ds_read_b64_tr_b16 v[34:35], v23 offset:9216
  ds_read_b64_tr_b16 v[36:37], v24 offset:8192
  ds_read_b64_tr_b16 v[38:39], v24 offset:9216
  ds_read_b128 v[40:43], v21 offset:0
  ds_read_b128 v[44:47], v21 offset:4096
  s_waitcnt lgkmcnt(6)
  v_mfma_f32_32x32x16_bf16 v[64:79], v[56:59], v[48:51], v[64:79]
  v_mfma_f32_32x32x16_bf16 v[80:95], v[60:63], v[48:51], v[80:95]
  v_mfma_f32_32x32x16_bf16 v[96:111], v[56:59], v[52:55], v[96:111]
  v_mfma_f32_32x32x16_bf16 v[112:127], v[60:63], v[52:55], v[112:127]
  ds_read_b64_tr_b16 v[48:49], v23 offset:12288
  ds_read_b64_tr_b16 v[50:51], v23 offset:13312
  ds_read_b64_tr_b16 v[52:53], v24 offset:12288
  ds_read_b64_tr_b16 v[54:55], v24 offset:13312
  ds_read_b128 v[56:59], v22 offset:0
  ds_read_b128 v[60:63], v22 offset:4096
  s_waitcnt lgkmcnt(6)
  v_mfma_f32_32x32x16_bf16 v[64:79], v[40:43], v[32:35], v[64:79]
  v_mfma_f32_32x32x16_bf16 v[80:95], v[44:47], v[32:35], v[80:95]
  v_mfma_f32_32x32x16_bf16 v[96:111], v[40:43], v[36:39], v[96:111]
  v_mfma_f32_32x32x16_bf16 v[112:127], v[44:47], v[36:39], v[112:127]
  s_add_u32 s40, s40, 32768
  s_and_b32 s40, s40, 131071
  s_add_u32 s41, s41, 1
  s_cmp_lt_u32 s41, s47
  s_waitcnt lgkmcnt(0)
  s_cbranch_scc1 concat_heads__sliding_block__mha_block__prompt_kernel_qV_loop
  v_mfma_f32_32x32x16_bf16 v[64:79], v[56:59], v[48:51], v[64:79]
  v_mfma_f32_32x32x16_bf16 v[80:95], v[60:63], v[48:51], v[80:95]
  v_mfma_f32_32x32x16_bf16 v[96:111], v[56:59], v[52:55], v[96:111]
  v_mfma_f32_32x32x16_bf16 v[112:127], v[60:63], v[52:55], v[112:127]
  s_cmp_eq_u32 s44, 0
  s_cbranch_scc0 cb_23
  s_barrier
cb_23:
  s_lshl_b32 s39, s42, 6
  s_lshl_b32 s43, s34, 2
  s_add_u32 s39, s39, s43
  s_lshl_b32 s43, s46, 1
  s_add_u32 s39, s39, s43
  s_mul_i32 s39, s39, 81920
  s_add_u32 s51, s39, 5242880
  s_add_u32 s52, s51, 81920
  s_lshl_b32 s39, s37, 7
  s_lshl_b32 s43, s45, 6
  s_add_u32 s39, s39, s43
  v_and_b32 v2, 31, v1
  v_add_u32 v2, s39, v2
  v_lshlrev_b32 v2, 4, v2
  v_lshrrev_b32 v3, 5, v1
  v_mul_u32_u24 v3, 10240, v3
  v_add_u32 v25, v2, v3
  v_add_u32 v25, 40960, v25
  v_add_u32 v26, 20480, v25
  s_cmp_eq_u32 s44, 0
  s_cbranch_scc1 concat_heads__sliding_block__mha_block__prompt_kernel_h2s
  s_waitcnt lgkmcnt(0)
  v_mov_b32 v10, 163608
  s_mov_b32 s53, 0
concat_heads__sliding_block__mha_block__prompt_kernel_h2:
  ds_read_b32 v11, v10
  s_waitcnt lgkmcnt(0)
  v_readfirstlane_b32 s39, v11
  s_add_u32 s53, s53, 1
  s_cmp_ge_u32 s39, 4
  s_cbranch_scc1 concat_heads__sliding_block__mha_block__prompt_kernel_h2_ok
  s_sleep 1
  s_cmp_lt_u32 s53, 0x100000
  s_cbranch_scc1 concat_heads__sliding_block__mha_block__prompt_kernel_h2
concat_heads__sliding_block__mha_block__prompt_kernel_h2_ok:
concat_heads__sliding_block__mha_block__prompt_kernel_h2s:
  v_cvt_pk_bf16_f32 v32, v64, v65
  v_cvt_pk_bf16_f32 v33, v66, v67
  v_cvt_pk_bf16_f32 v34, v68, v69
  v_cvt_pk_bf16_f32 v35, v70, v71
  buffer_store_dwordx4 v[32:35], v25, s[12:15], s51 offen offset:0 sc1
  v_cvt_pk_bf16_f32 v36, v72, v73
  v_cvt_pk_bf16_f32 v37, v74, v75
  v_cvt_pk_bf16_f32 v38, v76, v77
  v_cvt_pk_bf16_f32 v39, v78, v79
  buffer_store_dwordx4 v[36:39], v26, s[12:15], s51 offen offset:0 sc1
  v_cvt_pk_bf16_f32 v40, v80, v81
  v_cvt_pk_bf16_f32 v41, v82, v83
  v_cvt_pk_bf16_f32 v42, v84, v85
  v_cvt_pk_bf16_f32 v43, v86, v87
  buffer_store_dwordx4 v[40:43], v25, s[12:15], s52 offen offset:0 sc1
  v_cvt_pk_bf16_f32 v44, v88, v89
  v_cvt_pk_bf16_f32 v45, v90, v91
  v_cvt_pk_bf16_f32 v46, v92, v93
  v_cvt_pk_bf16_f32 v47, v94, v95
  buffer_store_dwordx4 v[44:47], v26, s[12:15], s52 offen offset:0 sc1
  v_cvt_pk_bf16_f32 v48, v96, v97
  v_cvt_pk_bf16_f32 v49, v98, v99
  v_cvt_pk_bf16_f32 v50, v100, v101
  v_cvt_pk_bf16_f32 v51, v102, v103
  buffer_store_dwordx4 v[48:51], v25, s[12:15], s51 offen offset:512 sc1
  v_cvt_pk_bf16_f32 v52, v104, v105
  v_cvt_pk_bf16_f32 v53, v106, v107
  v_cvt_pk_bf16_f32 v54, v108, v109
  v_cvt_pk_bf16_f32 v55, v110, v111
  buffer_store_dwordx4 v[52:55], v26, s[12:15], s51 offen offset:512 sc1
  v_cvt_pk_bf16_f32 v56, v112, v113
  v_cvt_pk_bf16_f32 v57, v114, v115
  v_cvt_pk_bf16_f32 v58, v116, v117
  v_cvt_pk_bf16_f32 v59, v118, v119
  buffer_store_dwordx4 v[56:59], v25, s[12:15], s52 offen offset:512 sc1
  v_cvt_pk_bf16_f32 v60, v120, v121
  v_cvt_pk_bf16_f32 v61, v122, v123
  v_cvt_pk_bf16_f32 v62, v124, v125
  v_cvt_pk_bf16_f32 v63, v126, v127
  buffer_store_dwordx4 v[60:63], v26, s[12:15], s52 offen offset:512 sc1
  s_cmp_eq_u32 s44, 0
  s_cbranch_scc0 cb_24
  s_barrier
cb_24:
  s_cmp_eq_u32 s44, 0
  s_cbranch_scc0 cb_25
  s_barrier
cb_25:
concat_heads__sliding_block__mha_block__prompt_kernel_qnext:
  s_cmp_eq_u32 s44, 0
  s_cbranch_scc0 concat_heads__sliding_block__mha_block__prompt_kernel_qdone
  v_mov_b32 v12, 163584
  v_mov_b32 v9, 1
  s_mov_b32 s53, 0
  s_mov_b32 s41, 13
concat_heads__sliding_block__mha_block__prompt_kernel_qrep:
  s_cmp_lg_u32 s53, 0
  s_cbranch_scc1 rep_26
  s_getreg_b32 s52, hwreg(HW_REG_IB_STS)
  s_and_b32 s52, s52, 0x00c0000f
  s_cbranch_scc1 rep_26
  s_mov_b32 s53, 1
  s_mov_b64 exec, 1
  ds_add_rtn_u32 v8, v12, v9
  s_mov_b64 exec, -1
  s_waitcnt lgkmcnt(0)
  v_readfirstlane_b32 s52, v8
  s_nop 3
  s_cmp_eq_u32 s52, 3
  s_cbranch_scc0 rep_26
  s_add_u32 s51, s34, 16
  s_lshl_b32 s51, s51, 7
  s_add_u32 s51, s51, 25165824
  v_mov_b32 v20, 0
  v_mov_b32 v21, 1
  s_mov_b64 exec, 1
  buffer_atomic_add v21, v20, s[12:15], s51 offen sc1
  s_mov_b64 exec, -1
rep_26:
  s_barrier
  s_add_u32 s41, s41, 1
  s_cmp_lt_u32 s41, 20
  s_cbranch_scc1 concat_heads__sliding_block__mha_block__prompt_kernel_qrep
  s_cmp_lg_u32 s53, 0
  s_cbranch_scc1 rep_27
  s_waitcnt vmcnt(0)
  s_mov_b32 s53, 1
  s_mov_b64 exec, 1
  ds_add_rtn_u32 v8, v12, v9
  s_mov_b64 exec, -1
  s_waitcnt lgkmcnt(0)
  v_readfirstlane_b32 s52, v8
  s_nop 3
  s_cmp_eq_u32 s52, 3
  s_cbranch_scc0 rep_27
  s_add_u32 s51, s34, 16
  s_lshl_b32 s51, s51, 7
  s_add_u32 s51, s51, 25165824
  v_mov_b32 v20, 0
  v_mov_b32 v21, 1
  s_mov_b64 exec, 1
  buffer_atomic_add v21, v20, s[12:15], s51 offen sc1
  s_mov_b64 exec, -1
rep_27:
concat_heads__sliding_block__mha_block__prompt_kernel_qdone:
concat_heads__sliding_block__mha_block__prompt_kernel_c_attn:
  s_and_b32 s34, s2, 7
  s_lshr_b32 s35, s2, 3
  s_lshr_b32 s36, s35, 3
  s_lshl_b32 s34, s34, 2
  s_add_u32 s34, s34, s36
  s_and_b32 s35, s35, 7
  v_and_b32 v2, 31, v1
  v_lshrrev_b32 v3, 5, v1
  v_lshlrev_b32 v4, 3, v2
  v_lshl_add_u32 v143, v3, 9, v4
  v_add_u32 v5, 1024, v4
  v_mov_b32 v6, 0x40000000
  v_cmp_eq_u32 vcc, 0, v3
  s_and_b32 s36, s32, 3
  s_lshr_b32 s37, s32, 2
  s_lshl_b32 s38, s35, 3
  s_add_u32 s57, s38, s32
  s_lshl_b32 s39, s36, 1
  s_add_u32 s38, s38, s39
  s_add_u32 s39, s38, 1
  v_lshlrev_b32 v4, 4, v2
  v_lshl_add_u32 v148, v3, 9, v4
  v_cndmask_b32 v149, v6, v4, vcc
  v_mov_b32 v6, 196608
  v_cndmask_b32 v144, v6, v5, vcc
  v_mul_u32_u24 v5, 336, v3
  v_lshl_add_u32 v5, v2, 4, v5
  v_cmp_gt_u32 vcc, 21, v2
  s_lshl_b32 s58, s34, 10
  s_lshr_b32 s59, s34, 2
  v_cndmask_b32 v145, v6, v5, vcc
  s_lshl_b32 s59, s59, 10
  s_bfe_u32 s40, s34, 0x10001
  s_lshl_b32 s40, s40, 9
  s_add_u32 s59, s59, s40
  s_and_b32 s40, s34, 1
  s_lshl_b32 s40, s40, 3
  s_add_u32 s59, s59, s40
  s_add_u32 s59, s59, 32768
  v_mov_b32 v167, 0x71800000
  s_mul_i32 s40, s37, 10496
  s_add_u32 s40, s40, 10240
  v_mov_b32 v92, 0
  v_mov_b32 v93, 0
  v_mov_b32 v94, 0
  v_mov_b32 v95, 0
  v_mov_b32 v96, 0
  v_mov_b32 v97, 0
  v_mov_b32 v98, 0
  v_mov_b32 v99, 0
  v_mov_b32 v100, 0
  v_mov_b32 v101, 0
  v_mov_b32 v102, 0
  v_mov_b32 v103, 0
  v_mov_b32 v104, 0
  v_mov_b32 v105, 0
  v_mov_b32 v106, 0
  v_mov_b32 v107, 0
  v_mov_b32 v108, 0
  v_mov_b32 v109, 0
  v_mov_b32 v110, 0
  v_mov_b32 v111, 0
  v_mov_b32 v112, 0
  v_mov_b32 v113, 0
  v_mov_b32 v114, 0
  v_mov_b32 v115, 0
  v_mov_b32 v116, 0
  v_mov_b32 v117, 0
  v_mov_b32 v118, 0
  v_mov_b32 v119, 0
  v_mov_b32 v120, 0
  v_mov_b32 v121, 0
  v_mov_b32 v122, 0
  v_mov_b32 v123, 0
  v_mov_b32 v84, 0
  v_mov_b32 v85, 0
  v_mov_b32 v86, 0
  v_mov_b32 v87, 0
  v_mov_b32 v88, 0
  v_mov_b32 v89, 0
  v_mov_b32 v90, 0
  v_mov_b32 v91, 0
  v_mov_b32 v136, 0
  v_mov_b32 v137, 0
  v_mov_b32 v138, 0
  v_mov_b32 v139, 0
  s_cmp_eq_u32 s32, 0
  s_cbranch_scc0 concat_heads__sliding_block__mha_block__prompt_kernel_noones
  v_mov_b32 v52, 0x3f803f80
  v_mov_b32 v53, 0x3f803f80
  v_mov_b32 v54, 0x3f803f80
  v_mov_b32 v55, 0x3f803f80
  v_add_u32 v2, 0, v1
  v_lshrrev_b32 v3, 2, v2
  v_mul_u32_u24 v3, 2624, v3
  v_and_b32 v4, 3, v2
  v_mul_u32_u24 v4, 336, v4
  v_add_u32 v3, v3, v4
  v_add_u32 v3, 11840, v3
  s_mov_b32 exec_hi, 0
  ds_write_b128 v3, v[52:55]
  s_mov_b64 exec, -1
concat_heads__sliding_block__mha_block__prompt_kernel_noones:
  s_mov_b32 s50, 0
  s_mov_b64 s[52:53], 0
  s_waitcnt lgkmcnt(0)
  s_barrier
  s_cmp_eq_u32 s32, 0
  s_cbranch_scc0 concat_heads__sliding_block__mha_block__prompt_kernel_noones2
  v_mov_b32 v52, 0x3f803f80
  v_mov_b32 v53, 0x3f803f80
  v_mov_b32 v54, 0x3f803f80
  v_mov_b32 v55, 0x3f803f80
  v_add_u32 v2, 0, v1
  v_lshrrev_b32 v3, 2, v2
  v_mul_u32_u24 v3, 2624, v3
  v_and_b32 v4, 3, v2
  v_mul_u32_u24 v4, 336, v4
  v_add_u32 v3, v3, v4
  v_add_u32 v3, 32832, v3
  ds_write_b128 v3, v[52:55]
  s_mov_b64 exec, -1
  v_mov_b32 v52, 0x3f803f80
  v_mov_b32 v53, 0x3f803f80
  v_mov_b32 v54, 0x3f803f80
  v_mov_b32 v55, 0x3f803f80
  v_add_u32 v2, 0, v1
  v_lshrrev_b32 v3, 2, v2
  v_mul_u32_u24 v3, 2624, v3
  v_and_b32 v4, 3, v2
  v_mul_u32_u24 v4, 336, v4
  v_add_u32 v3, v3, v4
  v_add_u32 v3, 74816, v3
  ds_write_b128 v3, v[52:55]
  s_mov_b64 exec, -1
concat_heads__sliding_block__mha_block__prompt_kernel_noones2:
  v_mov_b32 v2, 125440
  v_mov_b32 v3, 0
  ds_write_b32 v2, v3
  s_mul_i32 s41, s36, 2560
  s_add_u32 s41, s41, 0
  v_add_u32 v140, s41, v143
  v_add_u32 v141, s41, v144
  ds_read_b64 v[8:9], v140 offset:0
  ds_read_b64 v[10:11], v140 offset:256
  ds_read_b64 v[12:13], v141 offset:0
  ds_read_b64 v[14:15], v140 offset:1280
  ds_read_b64 v[16:17], v140 offset:1536
  ds_read_b64 v[18:19], v141 offset:1280
  v_add_u32 v140, 10240, v143
  v_add_u32 v141, 10240, v144
  ds_read_b64 v[124:125], v140 offset:0
  ds_read_b64 v[126:127], v140 offset:256
  ds_read_b64 v[128:129], v141 offset:0
  s_waitcnt lgkmcnt(0)
  v_mfma_f32_32x32x16_bf16 v[52:67], v[124:127], v[8:11], 0
  v_mfma_f32_32x32x16_bf16 v[68:83], v[124:127], v[14:17], 0
  v_mfma_f32_32x32x8_bf16 v[52:67], v[128:129], v[12:13], v[52:67]
  v_mfma_f32_32x32x8_bf16 v[68:83], v[128:129], v[18:19], v[68:83]
  s_nop 15
  v_max3_f32 v156, v52, v53, v54
  v_max3_f32 v156, v55, v56, v156
  v_max3_f32 v156, v57, v58, v156
  v_max3_f32 v156, v59, v60, v156
  v_max3_f32 v156, v61, v62, v156
  v_max3_f32 v156, v63, v64, v156
  v_max3_f32 v156, v65, v66, v156
  v_max_f32 v156, v67, v156
  v_max3_f32 v157, v68, v69, v70
  v_max3_f32 v157, v71, v72, v157
  v_max3_f32 v157, v73, v74, v157
  v_max3_f32 v157, v75, v76, v157
  v_max3_f32 v157, v77, v78, v157
  v_max3_f32 v157, v79, v80, v157
  v_max3_f32 v157, v81, v82, v157
  v_max_f32 v157, v83, v157
  v_mov_b32 v158, v156
  v_mov_b32 v159, v156
  s_nop 1
  v_permlane32_swap_b32 v158, v159
  s_nop 1
  v_max_f32 v156, v158, v159
  v_mov_b32 v158, v157
  v_mov_b32 v159, v157
  s_nop 1
  v_permlane32_swap_b32 v158, v159
  s_nop 1
  v_max_f32 v157, v158, v159
concat_heads__sliding_block__mha_block__prompt_kernel_Bstart:
  v_sub_f32 v20, 0, v156
  v_sub_f32 v21, 0, v156
  v_sub_f32 v22, 0, v156
  v_sub_f32 v23, 0, v156
  v_sub_f32 v24, 0, v156
  v_sub_f32 v25, 0, v156
  v_sub_f32 v26, 0, v156
  v_sub_f32 v27, 0, v156
  v_sub_f32 v28, 0, v156
  v_sub_f32 v29, 0, v156
  v_sub_f32 v30, 0, v156
  v_sub_f32 v31, 0, v156
  v_sub_f32 v32, 0, v156
  v_sub_f32 v33, 0, v156
  v_sub_f32 v34, 0, v156
  v_sub_f32 v35, 0, v156
  v_sub_f32 v36, 0, v157
  v_sub_f32 v37, 0, v157
  v_sub_f32 v38, 0, v157
  v_sub_f32 v39, 0, v157
  v_sub_f32 v40, 0, v157
  v_sub_f32 v41, 0, v157
  v_sub_f32 v42, 0, v157
  v_sub_f32 v43, 0, v157
  v_sub_f32 v44, 0, v157
  v_sub_f32 v45, 0, v157
  v_sub_f32 v46, 0, v157
  v_sub_f32 v47, 0, v157
  v_sub_f32 v48, 0, v157
  v_sub_f32 v49, 0, v157
  v_sub_f32 v50, 0, v157
  v_sub_f32 v51, 0, v157
  v_add_u32 v140, s40, v143
  v_add_u32 v141, s40, v144
  v_add_u32 v142, s40, v145
  ds_read_b64 v[124:125], v140 offset:0
  ds_read_b64 v[126:127], v140 offset:256
  ds_read_b64 v[128:129], v141 offset:0
  ds_read_b128 v[132:135], v142 offset:1280
  s_waitcnt lgkmcnt(1)
  v_mfma_f32_32x32x16_bf16 v[52:67], v[124:127], v[8:11], v[20:35]
  v_mfma_f32_32x32x8_bf16 v[52:67], v[128:129], v[12:13], v[52:67]
  s_nop 15
  s_mov_b32 s41, 0
  s_mov_b32 s42, 0
.p2align 6
concat_heads__sliding_block__mha_block__prompt_kernel_Bloop:
  s_setprio 3
  v_exp_f32 v52, v52
  v_exp_f32 v53, v53
  v_mfma_f32_32x32x16_bf16 v[108:123], v[136:139], v[88:91], v[108:123]
  ds_read_b128 v[136:139], v142 offset:1952
  v_exp_f32 v54, v54
  v_exp_f32 v55, v55
  v_exp_f32 v56, v56
  v_exp_f32 v57, v57
  v_mfma_f32_32x32x16_bf16 v[68:83], v[124:127], v[14:17], v[36:51]
  v_exp_f32 v58, v58
  v_exp_f32 v59, v59
  v_cvt_pk_bf16_f32 v84, v52, v53
  v_cvt_pk_bf16_f32 v85, v54, v55
  v_cvt_pk_bf16_f32 v86, v56, v57
  v_cvt_pk_bf16_f32 v87, v58, v59
  v_mfma_f32_32x32x8_bf16 v[68:83], v[128:129], v[18:19], v[68:83]
  ds_read_b64 v[124:125], v140 offset:2624
  ds_read_b64 v[126:127], v140 offset:2880
  ds_read_b64 v[128:129], v141 offset:2624
  v_exp_f32 v60, v60
  v_exp_f32 v61, v61
  v_exp_f32 v62, v62
  v_exp_f32 v63, v63
  s_waitcnt lgkmcnt(4)
  v_mfma_f32_32x32x16_bf16 v[92:107], v[132:135], v[84:87], v[92:107]
  v_exp_f32 v64, v64
  v_exp_f32 v65, v65
  v_exp_f32 v66, v66
  v_exp_f32 v67, v67
  v_cvt_pk_bf16_f32 v88, v60, v61
  v_cvt_pk_bf16_f32 v89, v62, v63
  v_cvt_pk_bf16_f32 v90, v64, v65
  v_cvt_pk_bf16_f32 v91, v66, v67
  s_setprio 2
  v_exp_f32 v68, v68
  v_exp_f32 v69, v69
  s_waitcnt lgkmcnt(3)
  v_mfma_f32_32x32x16_bf16 v[92:107], v[136:139], v[88:91], v[92:107]
  v_exp_f32 v70, v70
  v_exp_f32 v71, v71
  v_exp_f32 v72, v72
  v_exp_f32 v73, v73
  s_waitcnt lgkmcnt(0)
  v_mfma_f32_32x32x16_bf16 v[52:67], v[124:127], v[8:11], v[20:35]
  v_exp_f32 v74, v74
  v_exp_f32 v75, v75
  v_cvt_pk_bf16_f32 v84, v68, v69
  v_cvt_pk_bf16_f32 v85, v70, v71
  v_cvt_pk_bf16_f32 v86, v72, v73
  v_cvt_pk_bf16_f32 v87, v74, v75
  v_mfma_f32_32x32x8_bf16 v[52:67], v[128:129], v[12:13], v[52:67]
  v_exp_f32 v76, v76
  v_exp_f32 v77, v77
  v_exp_f32 v78, v78
  v_exp_f32 v79, v79
  v_mfma_f32_32x32x16_bf16 v[108:123], v[132:135], v[84:87], v[108:123]
  ds_read_b128 v[132:135], v142 offset:3904
  v_exp_f32 v80, v80
  v_exp_f32 v81, v81
  v_exp_f32 v82, v82
  v_exp_f32 v83, v83
  v_cvt_pk_bf16_f32 v88, v76, v77
  v_cvt_pk_bf16_f32 v89, v78, v79
  v_cvt_pk_bf16_f32 v90, v80, v81
  v_cvt_pk_bf16_f32 v91, v82, v83
  s_setprio 3
  v_exp_f32 v52, v52
  v_exp_f32 v53, v53
  v_mfma_f32_32x32x16_bf16 v[108:123], v[136:139], v[88:91], v[108:123]
  ds_read_b128 v[136:139], v142 offset:4576
  v_exp_f32 v54, v54
  v_exp_f32 v55, v55
  v_exp_f32 v56, v56
  v_exp_f32 v57, v57
  v_mfma_f32_32x32x16_bf16 v[68:83], v[124:127], v[14:17], v[36:51]
  v_exp_f32 v58, v58
  v_exp_f32 v59, v59
  v_cvt_pk_bf16_f32 v84, v52, v53
  v_cvt_pk_bf16_f32 v85, v54, v55
  v_cvt_pk_bf16_f32 v86, v56, v57
  v_cvt_pk_bf16_f32 v87, v58, v59
  v_mfma_f32_32x32x8_bf16 v[68:83], v[128:129], v[18:19], v[68:83]
  ds_read_b64 v[124:125], v140 offset:5248
  ds_read_b64 v[126:127], v140 offset:5504
  ds_read_b64 v[128:129], v141 offset:5248
  v_exp_f32 v60, v60
  v_exp_f32 v61, v61
  v_exp_f32 v62, v62
  v_exp_f32 v63, v63
  s_waitcnt lgkmcnt(4)
  v_mfma_f32_32x32x16_bf16 v[92:107], v[132:135], v[84:87], v[92:107]
  v_exp_f32 v64, v64
  v_exp_f32 v65, v65
  v_exp_f32 v66, v66
  v_exp_f32 v67, v67
  v_cvt_pk_bf16_f32 v88, v60, v61
  v_cvt_pk_bf16_f32 v89, v62, v63
  v_cvt_pk_bf16_f32 v90, v64, v65
  v_cvt_pk_bf16_f32 v91, v66, v67
  s_setprio 2
  v_exp_f32 v68, v68
  v_exp_f32 v69, v69
  s_waitcnt lgkmcnt(3)
  v_mfma_f32_32x32x16_bf16 v[92:107], v[136:139], v[88:91], v[92:107]
  v_exp_f32 v70, v70
  v_exp_f32 v71, v71
  v_exp_f32 v72, v72
  v_exp_f32 v73, v73
  s_waitcnt lgkmcnt(0)
  v_mfma_f32_32x32x16_bf16 v[52:67], v[124:127], v[8:11], v[20:35]
  v_exp_f32 v74, v74
  v_exp_f32 v75, v75
  v_cvt_pk_bf16_f32 v84, v68, v69
  v_cvt_pk_bf16_f32 v85, v70, v71
  v_cvt_pk_bf16_f32 v86, v72, v73
  v_cvt_pk_bf16_f32 v87, v74, v75
  v_mfma_f32_32x32x8_bf16 v[52:67], v[128:129], v[12:13], v[52:67]
  v_exp_f32 v76, v76
  v_exp_f32 v77, v77
  v_exp_f32 v78, v78
  v_exp_f32 v79, v79
  v_mfma_f32_32x32x16_bf16 v[108:123], v[132:135], v[84:87], v[108:123]
  ds_read_b128 v[132:135], v142 offset:6528
  v_exp_f32 v80, v80
  v_exp_f32 v81, v81
  v_exp_f32 v82, v82
  v_exp_f32 v83, v83
  v_cvt_pk_bf16_f32 v88, v76, v77
  v_cvt_pk_bf16_f32 v89, v78, v79
  v_cvt_pk_bf16_f32 v90, v80, v81
  v_cvt_pk_bf16_f32 v91, v82, v83
  s_setprio 1
  v_exp_f32 v52, v52
  v_exp_f32 v53, v53
  v_mfma_f32_32x32x16_bf16 v[108:123], v[136:139], v[88:91], v[108:123]
  ds_read_b128 v[136:139], v142 offset:7200
  v_exp_f32 v54, v54
  v_exp_f32 v55, v55
  v_exp_f32 v56, v56
  v_exp_f32 v57, v57
  v_mfma_f32_32x32x16_bf16 v[68:83], v[124:127], v[14:17], v[36:51]
  v_exp_f32 v58, v58
  v_exp_f32 v59, v59
  v_cvt_pk_bf16_f32 v84, v52, v53
  v_cvt_pk_bf16_f32 v85, v54, v55
  v_cvt_pk_bf16_f32 v86, v56, v57
  v_cvt_pk_bf16_f32 v87, v58, v59
  v_mfma_f32_32x32x8_bf16 v[68:83], v[128:129], v[18:19], v[68:83]
  ds_read_b64 v[124:125], v140 offset:7872
  ds_read_b64 v[126:127], v140 offset:8128
  ds_read_b64 v[128:129], v141 offset:7872
  v_exp_f32 v60, v60
  v_exp_f32 v61, v61
  v_exp_f32 v62, v62
  v_exp_f32 v63, v63
  s_waitcnt lgkmcnt(4)
  v_mfma_f32_32x32x16_bf16 v[92:107], v[132:135], v[84:87], v[92:107]
  v_exp_f32 v64, v64
  v_exp_f32 v65, v65
  v_exp_f32 v66, v66
  v_exp_f32 v67, v67
  v_cvt_pk_bf16_f32 v88, v60, v61
  v_cvt_pk_bf16_f32 v89, v62, v63
  v_cvt_pk_bf16_f32 v90, v64, v65
  v_cvt_pk_bf16_f32 v91, v66, v67
  s_setprio 0
  v_exp_f32 v68, v68
  v_exp_f32 v69, v69
  s_waitcnt lgkmcnt(3)
  v_mfma_f32_32x32x16_bf16 v[92:107], v[136:139], v[88:91], v[92:107]
  v_exp_f32 v70, v70
  v_exp_f32 v71, v71
  v_exp_f32 v72, v72
  v_exp_f32 v73, v73
  s_waitcnt lgkmcnt(0)
  v_mfma_f32_32x32x16_bf16 v[52:67], v[124:127], v[8:11], v[20:35]
  v_exp_f32 v74, v74
  v_exp_f32 v75, v75
  v_cvt_pk_bf16_f32 v84, v68, v69
  v_cvt_pk_bf16_f32 v85, v70, v71
  v_cvt_pk_bf16_f32 v86, v72, v73
  v_cvt_pk_bf16_f32 v87, v74, v75
  v_mfma_f32_32x32x8_bf16 v[52:67], v[128:129], v[12:13], v[52:67]
  v_exp_f32 v76, v76
  v_exp_f32 v77, v77
  v_exp_f32 v78, v78
  v_exp_f32 v79, v79
  v_mfma_f32_32x32x16_bf16 v[108:123], v[132:135], v[84:87], v[108:123]
  ds_read_b128 v[132:135], v142 offset:9152
  v_exp_f32 v80, v80
  v_exp_f32 v81, v81
  v_exp_f32 v82, v82
  v_exp_f32 v83, v83
  v_cvt_pk_bf16_f32 v88, v76, v77
  v_cvt_pk_bf16_f32 v89, v78, v79
  v_cvt_pk_bf16_f32 v90, v80, v81
  v_cvt_pk_bf16_f32 v91, v82, v83
  s_setprio 1
  v_exp_f32 v52, v52
  v_exp_f32 v53, v53
  v_mfma_f32_32x32x16_bf16 v[108:123], v[136:139], v[88:91], v[108:123]
  ds_read_b128 v[136:139], v142 offset:9824
  v_exp_f32 v54, v54
  v_exp_f32 v55, v55
  v_exp_f32 v56, v56
  v_exp_f32 v57, v57
  v_mfma_f32_32x32x16_bf16 v[68:83], v[124:127], v[14:17], v[36:51]
  v_exp_f32 v58, v58
  v_exp_f32 v59, v59
  v_cvt_pk_bf16_f32 v84, v52, v53
  v_cvt_pk_bf16_f32 v85, v54, v55
  v_cvt_pk_bf16_f32 v86, v56, v57
  v_cvt_pk_bf16_f32 v87, v58, v59
  v_mfma_f32_32x32x8_bf16 v[68:83], v[128:129], v[18:19], v[68:83]
  s_add_u32 s42, s42, 20992
  s_cmp_eq_u32 s42, 62976
  s_cselect_b32 s42, 0, s42
  s_add_u32 s43, s42, s40
  s_cmp_eq_u32 s41, 7
  s_cbranch_scc1 concat_heads__sliding_block__mha_block__prompt_kernel_nobar
  s_waitcnt vmcnt(0)
  s_barrier
concat_heads__sliding_block__mha_block__prompt_kernel_nobar:
  v_add_u32 v140, s43, v143
  v_add_u32 v141, s43, v144
  ds_read_b64 v[124:125], v140 offset:0
  ds_read_b64 v[126:127], v140 offset:256
  ds_read_b64 v[128:129], v141 offset:0
  v_exp_f32 v60, v60
  v_exp_f32 v61, v61
  v_exp_f32 v62, v62
  v_exp_f32 v63, v63
  s_waitcnt lgkmcnt(4)
  v_mfma_f32_32x32x16_bf16 v[92:107], v[132:135], v[84:87], v[92:107]
  v_exp_f32 v64, v64
  v_exp_f32 v65, v65
  v_exp_f32 v66, v66
  v_exp_f32 v67, v67
  v_cvt_pk_bf16_f32 v88, v60, v61
  v_cvt_pk_bf16_f32 v89, v62, v63
  v_cvt_pk_bf16_f32 v90, v64, v65
  v_cvt_pk_bf16_f32 v91, v66, v67
  s_setprio 0
  v_exp_f32 v68, v68
  v_exp_f32 v69, v69
  s_waitcnt lgkmcnt(3)
  v_mfma_f32_32x32x16_bf16 v[92:107], v[136:139], v[88:91], v[92:107]
  v_exp_f32 v70, v70
  v_exp_f32 v71, v71
  v_exp_f32 v72, v72
  v_exp_f32 v73, v73
  s_waitcnt lgkmcnt(0)
  v_mfma_f32_32x32x16_bf16 v[52:67], v[124:127], v[8:11], v[20:35]
  v_exp_f32 v74, v74
  v_exp_f32 v75, v75
  v_cvt_pk_bf16_f32 v84, v68, v69
  v_cvt_pk_bf16_f32 v85, v70, v71
  v_cvt_pk_bf16_f32 v86, v72, v73
  v_cvt_pk_bf16_f32 v87, v74, v75
  v_mfma_f32_32x32x8_bf16 v[52:67], v[128:129], v[12:13], v[52:67]
  v_exp_f32 v76, v76
  v_exp_f32 v77, v77
  v_exp_f32 v78, v78
  v_exp_f32 v79, v79
  v_mfma_f32_32x32x16_bf16 v[108:123], v[132:135], v[84:87], v[108:123]
  v_add_u32 v142, s43, v145
  ds_read_b128 v[132:135], v142 offset:1280
  v_exp_f32 v80, v80
  v_exp_f32 v81, v81
  v_exp_f32 v82, v82
  v_exp_f32 v83, v83
  v_cvt_pk_bf16_f32 v88, v76, v77
  v_cvt_pk_bf16_f32 v89, v78, v79
  v_cvt_pk_bf16_f32 v90, v80, v81
  v_cvt_pk_bf16_f32 v91, v82, v83
  s_add_u32 s41, s41, 1
  s_cmp_lt_u32 s41, 8
  s_cbranch_scc1 concat_heads__sliding_block__mha_block__prompt_kernel_Bloop
  s_nop 1
  v_mfma_f32_32x32x16_bf16 v[108:123], v[136:139], v[88:91], v[108:123]
  s_waitcnt lgkmcnt(0)
  s_mul_i32 s44, s36, 6144
  s_add_u32 s44, s44, 131072
  v_lshlrev_b32 v2, 4, v1
  v_add_u32 v2, s44, v2
  s_cmp_eq_u32 s37, 0
  s_cbranch_scc1 concat_heads__sliding_block__mha_block__prompt_kernel_c0
  s_nop 9
  ds_write_b128 v2, v[92:95] offset:3072
  ds_write_b128 v2, v[96:99] offset:4096
  ds_write_b128 v2, v[100:103] offset:5120
  v_and_b32 v6, 31, v1
  v_lshrrev_b32 v3, 5, v1
  v_lshlrev_b32 v4, 2, v3
  v_sub_u32 v4, v6, v4
  v_mov_b32 v5, 0xf149f2ca
  v_cmp_le_i32 s[42:43], 0, v4
  v_cmp_le_i32 s[44:45], 1, v4
  v_cmp_le_i32 s[46:47], 2, v4
  v_cmp_le_i32 s[48:49], 3, v4
  v_cndmask_b32 v36, v5, 0, s[42:43]
  v_cndmask_b32 v37, v5, 0, s[44:45]
  v_cndmask_b32 v38, v5, 0, s[46:47]
  v_cndmask_b32 v39, v5, 0, s[48:49]
  v_cmp_le_i32 s[42:43], 8, v4
  v_cmp_le_i32 s[44:45], 9, v4
  v_cmp_le_i32 s[46:47], 10, v4
  v_cmp_le_i32 s[48:49], 11, v4
  v_cndmask_b32 v40, v5, 0, s[42:43]
  v_cndmask_b32 v41, v5, 0, s[44:45]
  v_cndmask_b32 v42, v5, 0, s[46:47]
  v_cndmask_b32 v43, v5, 0, s[48:49]
  v_cmp_le_i32 s[42:43], 16, v4
  v_cmp_le_i32 s[44:45], 17, v4
  v_cmp_le_i32 s[46:47], 18, v4
  v_cmp_le_i32 s[48:49], 19, v4
  v_cndmask_b32 v44, v5, 0, s[42:43]
  v_cndmask_b32 v45, v5, 0, s[44:45]
  v_cndmask_b32 v46, v5, 0, s[46:47]
  v_cndmask_b32 v47, v5, 0, s[48:49]
  v_cmp_le_i32 s[42:43], 24, v4
  v_cmp_le_i32 s[44:45], 25, v4
  v_cmp_le_i32 s[46:47], 26, v4
  v_cmp_le_i32 s[48:49], 27, v4
  v_cndmask_b32 v48, v5, 0, s[42:43]
  v_cndmask_b32 v49, v5, 0, s[44:45]
  v_cndmask_b32 v50, v5, 0, s[46:47]
  v_cndmask_b32 v51, v5, 0, s[48:49]
  s_waitcnt lgkmcnt(0)
  s_barrier
  s_mul_i32 s41, s32, 1280
  s_add_u32 s41, s41, 115200
  v_add_u32 v140, s41, v143
  v_add_u32 v141, s41, v144
  ds_read_b64 v[150:151], v140 offset:0
  ds_read_b64 v[152:153], v140 offset:256
  ds_read_b64 v[154:155], v141 offset:0
  ds_read_b128 v[52:55], v2 offset:0
  ds_read_b128 v[56:59], v2 offset:1024
  ds_read_b128 v[60:63], v2 offset:2048
  s_waitcnt lgkmcnt(0)
  v_add_f32 v108, v108, v52
  v_add_f32 v109, v109, v53
  v_add_f32 v110, v110, v54
  v_add_f32 v111, v111, v55
  v_add_f32 v112, v112, v56
  v_add_f32 v113, v113, v57
  v_add_f32 v114, v114, v58
  v_add_f32 v115, v115, v59
  v_add_f32 v116, v116, v60
  v_add_f32 v117, v117, v61
  v_add_f32 v118, v118, v62
  v_add_f32 v119, v119, v63
  v_mov_b32 v156, v116
  v_mov_b32 v157, v116
  s_nop 1
  v_permlane32_swap_b32 v156, v157
  s_nop 1
  v_rcp_f32 v156, v157
  v_cmp_nlt_f32 vcc, v157, v167
  v_mul_f32 v108, v108, v156
  v_mul_f32 v109, v109, v156
  v_mul_f32 v110, v110, v156
  v_mul_f32 v111, v111, v156
  v_mul_f32 v112, v112, v156
  v_mul_f32 v113, v113, v156
  v_mul_f32 v114, v114, v156
  v_mul_f32 v115, v115, v156
  v_mul_f32 v116, v116, v156
  v_mul_f32 v117, v117, v156
  v_mul_f32 v118, v118, v156
  v_mul_f32 v119, v119, v156
  s_or_b64 s[52:53], s[52:53], vcc
  v_cvt_pk_bf16_f32 v158, v108, v109
  v_cvt_pk_bf16_f32 v159, v110, v111
  v_cvt_pk_bf16_f32 v160, v112, v113
  v_cvt_pk_bf16_f32 v161, v114, v115
  v_cvt_pk_bf16_f32 v162, v116, v117
  v_cvt_pk_bf16_f32 v163, v118, v119
  v_add_f32 v157, |v108|, |v109|
  v_add_f32 v157, |v110|, v157
  v_add_f32 v157, |v111|, v157
  v_add_f32 v157, |v112|, v157
  v_add_f32 v157, |v113|, v157
  v_add_f32 v157, |v114|, v157
  v_add_f32 v157, |v115|, v157
  v_add_f32 v157, |v116|, v157
  v_add_f32 v157, |v117|, v157
  v_add_f32 v157, |v118|, v157
  v_add_f32 v157, |v119|, v157
  v_cmp_nlt_f32 vcc, v157, v167
  s_add_u32 s60, s39, 64
  s_mul_i32 s60, s60, 40960
  s_add_u32 s60, s60, 16777216
  s_add_u32 s61, s60, s59
  s_add_u32 s60, s60, s58
  s_or_b64 s[52:53], s[52:53], vcc
  buffer_store_dwordx4 v[158:161], v148, s[12:15], s60 offen sc1
  buffer_store_dwordx2 v[162:163], v149, s[12:15], s61 offen sc1
  s_branch concat_heads__sliding_block__mha_block__prompt_kernel_c05
concat_heads__sliding_block__mha_block__prompt_kernel_c0:
  s_nop 9
  ds_write_b128 v2, v[108:111] offset:0
  ds_write_b128 v2, v[112:115] offset:1024
  ds_write_b128 v2, v[116:119] offset:2048
  v_and_b32 v6, 31, v1
  v_lshrrev_b32 v3, 5, v1
  v_lshlrev_b32 v4, 2, v3
  v_sub_u32 v4, v6, v4
  v_mov_b32 v5, 0xf149f2ca
  v_cmp_le_i32 s[42:43], 0, v4
  v_cmp_le_i32 s[44:45], 1, v4
  v_cmp_le_i32 s[46:47], 2, v4
  v_cmp_le_i32 s[48:49], 3, v4
  v_cndmask_b32 v36, v5, 0, s[42:43]
  v_cndmask_b32 v37, v5, 0, s[44:45]
  v_cndmask_b32 v38, v5, 0, s[46:47]
  v_cndmask_b32 v39, v5, 0, s[48:49]
  v_cmp_le_i32 s[42:43], 8, v4
  v_cmp_le_i32 s[44:45], 9, v4
  v_cmp_le_i32 s[46:47], 10, v4
  v_cmp_le_i32 s[48:49], 11, v4
  v_cndmask_b32 v40, v5, 0, s[42:43]
  v_cndmask_b32 v41, v5, 0, s[44:45]
  v_cndmask_b32 v42, v5, 0, s[46:47]
  v_cndmask_b32 v43, v5, 0, s[48:49]
  v_cmp_le_i32 s[42:43], 16, v4
  v_cmp_le_i32 s[44:45], 17, v4
  v_cmp_le_i32 s[46:47], 18, v4
  v_cmp_le_i32 s[48:49], 19, v4
  v_cndmask_b32 v44, v5, 0, s[42:43]
  v_cndmask_b32 v45, v5, 0, s[44:45]
  v_cndmask_b32 v46, v5, 0, s[46:47]
  v_cndmask_b32 v47, v5, 0, s[48:49]
  v_cmp_le_i32 s[42:43], 24, v4
  v_cmp_le_i32 s[44:45], 25, v4
  v_cmp_le_i32 s[46:47], 26, v4
  v_cmp_le_i32 s[48:49], 27, v4
  v_cndmask_b32 v48, v5, 0, s[42:43]
  v_cndmask_b32 v49, v5, 0, s[44:45]
  v_cndmask_b32 v50, v5, 0, s[46:47]
  v_cndmask_b32 v51, v5, 0, s[48:49]
  s_waitcnt lgkmcnt(0)
  s_barrier
  s_mul_i32 s41, s32, 1280
  s_add_u32 s41, s41, 115200
  v_add_u32 v140, s41, v143
  v_add_u32 v141, s41, v144
  ds_read_b64 v[150:151], v140 offset:0
  ds_read_b64 v[152:153], v140 offset:256
  ds_read_b64 v[154:155], v141 offset:0
  ds_read_b128 v[52:55], v2 offset:3072
  ds_read_b128 v[56:59], v2 offset:4096
  ds_read_b128 v[60:63], v2 offset:5120
  s_waitcnt lgkmcnt(0)
  v_add_f32 v92, v92, v52
  v_add_f32 v93, v93, v53
  v_add_f32 v94, v94, v54
  v_add_f32 v95, v95, v55
  v_add_f32 v96, v96, v56
  v_add_f32 v97, v97, v57
  v_add_f32 v98, v98, v58
  v_add_f32 v99, v99, v59
  v_add_f32 v100, v100, v60
  v_add_f32 v101, v101, v61
  v_add_f32 v102, v102, v62
  v_add_f32 v103, v103, v63
  v_mov_b32 v156, v100
  v_mov_b32 v157, v100
  s_nop 1
  v_permlane32_swap_b32 v156, v157
  s_nop 1
  v_rcp_f32 v156, v157
  v_cmp_nlt_f32 vcc, v157, v167
  v_mul_f32 v92, v92, v156
  v_mul_f32 v93, v93, v156
  v_mul_f32 v94, v94, v156
  v_mul_f32 v95, v95, v156
  v_mul_f32 v96, v96, v156
  v_mul_f32 v97, v97, v156
  v_mul_f32 v98, v98, v156
  v_mul_f32 v99, v99, v156
  v_mul_f32 v100, v100, v156
  v_mul_f32 v101, v101, v156
  v_mul_f32 v102, v102, v156
  v_mul_f32 v103, v103, v156
  s_or_b64 s[52:53], s[52:53], vcc
  v_cvt_pk_bf16_f32 v158, v92, v93
  v_cvt_pk_bf16_f32 v159, v94, v95
  v_cvt_pk_bf16_f32 v160, v96, v97
  v_cvt_pk_bf16_f32 v161, v98, v99
  v_cvt_pk_bf16_f32 v162, v100, v101
  v_cvt_pk_bf16_f32 v163, v102, v103
  v_add_f32 v157, |v92|, |v93|
  v_add_f32 v157, |v94|, v157
  v_add_f32 v157, |v95|, v157
  v_add_f32 v157, |v96|, v157
  v_add_f32 v157, |v97|, v157
  v_add_f32 v157, |v98|, v157
  v_add_f32 v157, |v99|, v157
  v_add_f32 v157, |v100|, v157
  v_add_f32 v157, |v101|, v157
  v_add_f32 v157, |v102|, v157
  v_add_f32 v157, |v103|, v157
  v_cmp_nlt_f32 vcc, v157, v167
  s_add_u32 s60, s38, 64
  s_mul_i32 s60, s60, 40960
  s_add_u32 s60, s60, 16777216
  s_add_u32 s61, s60, s59
  s_add_u32 s60, s60, s58
  s_or_b64 s[52:53], s[52:53], vcc
  buffer_store_dwordx4 v[158:161], v148, s[12:15], s60 offen sc1
  buffer_store_dwordx2 v[162:163], v149, s[12:15], s61 offen sc1
concat_heads__sliding_block__mha_block__prompt_kernel_c05:
  s_cmp_eq_u64 s[52:53], 0
  s_cbranch_scc1 concat_heads__sliding_block__mha_block__prompt_kernel_c1
  v_mov_b32 v2, 125440
  v_mov_b32 v3, 1
  ds_write_b32 v2, v3
concat_heads__sliding_block__mha_block__prompt_kernel_c1:
  s_cmp_eq_u32 s50, 2
  s_cbranch_scc1 concat_heads__sliding_block__mha_block__prompt_kernel_fin
  s_sub_i32 s44, 8, s57
  s_max_i32 s44, s44, 0
  s_add_u32 s45, s32, s44
  s_mul_i32 s45, s45, 2624
  s_add_u32 s45, s45, 73216
  s_cmp_eq_u32 s44, 8
  s_cselect_b32 s46, 8, 7
  s_add_u32 s46, s46, s32
  s_mul_i32 s46, s46, 2624
  s_add_u32 s46, s46, 73216
  v_add_u32 v140, s46, v143
  v_add_u32 v141, s46, v144
  ds_read_b64 v[124:125], v140 offset:0
  ds_read_b64 v[126:127], v140 offset:256
  ds_read_b64 v[128:129], v141 offset:0
  s_cmp_eq_u32 s44, 8
  s_cbranch_scc1 concat_heads__sliding_block__mha_block__prompt_kernel_A_d
  s_waitcnt lgkmcnt(0)
  v_mfma_f32_32x32x16_bf16 v[52:67], v[124:127], v[150:153], 0
  s_branch concat_heads__sliding_block__mha_block__prompt_kernel_A_e
concat_heads__sliding_block__mha_block__prompt_kernel_A_d:
  s_waitcnt lgkmcnt(0)
  v_mfma_f32_32x32x16_bf16 v[52:67], v[124:127], v[150:153], v[36:51]
concat_heads__sliding_block__mha_block__prompt_kernel_A_e:
  v_mfma_f32_32x32x8_bf16 v[52:67], v[128:129], v[154:155], v[52:67]
  s_nop 15
  v_max3_f32 v156, v52, v53, v54
  v_max3_f32 v156, v55, v56, v156
  v_max3_f32 v156, v57, v58, v156
  v_max3_f32 v156, v59, v60, v156
  v_max3_f32 v156, v61, v62, v156
  v_max3_f32 v156, v63, v64, v156
  v_max3_f32 v156, v65, v66, v156
  v_max_f32 v156, v67, v156
  v_mov_b32 v158, v156
  v_mov_b32 v159, v156
  s_nop 1
  v_permlane32_swap_b32 v158, v159
  s_nop 1
  v_max_f32 v156, v158, v159
  s_mov_b32 s51, 0
concat_heads__sliding_block__mha_block__prompt_kernel_Astart:
  v_sub_f32 v20, 0, v156
  v_mov_b32 v92, 0
  v_sub_f32 v21, 0, v156
  v_mov_b32 v93, 0
  v_sub_f32 v22, 0, v156
  v_mov_b32 v94, 0
  v_sub_f32 v23, 0, v156
  v_mov_b32 v95, 0
  v_sub_f32 v24, 0, v156
  v_mov_b32 v96, 0
  v_sub_f32 v25, 0, v156
  v_mov_b32 v97, 0
  v_sub_f32 v26, 0, v156
  v_mov_b32 v98, 0
  v_sub_f32 v27, 0, v156
  v_mov_b32 v99, 0
  v_sub_f32 v28, 0, v156
  v_mov_b32 v100, 0
  v_sub_f32 v29, 0, v156
  v_mov_b32 v101, 0
  v_sub_f32 v30, 0, v156
  v_mov_b32 v102, 0
  v_sub_f32 v31, 0, v156
  v_mov_b32 v103, 0
  v_sub_f32 v32, 0, v156
  v_mov_b32 v104, 0
  v_sub_f32 v33, 0, v156
  v_mov_b32 v105, 0
  v_sub_f32 v34, 0, v156
  v_mov_b32 v106, 0
  v_sub_f32 v35, 0, v156
  v_mov_b32 v107, 0
  v_mov_b32 v84, 0
  v_mov_b32 v85, 0
  v_mov_b32 v86, 0
  v_mov_b32 v87, 0
  v_mov_b32 v88, 0
  v_mov_b32 v89, 0
  v_mov_b32 v90, 0
  v_mov_b32 v91, 0
  v_mov_b32 v136, 0
  v_mov_b32 v137, 0
  v_mov_b32 v138, 0
  v_mov_b32 v139, 0
  v_add_u32 v140, s45, v143
  v_add_u32 v141, s45, v144
  v_add_u32 v142, s45, v145
  ds_read_b64 v[124:125], v140 offset:0
  ds_read_b64 v[126:127], v140 offset:256
  ds_read_b64 v[128:129], v141 offset:0
  ds_read_b128 v[132:135], v142 offset:1280
  s_cmp_eq_u32 s44, 0
  s_cbranch_scc1 concat_heads__sliding_block__mha_block__prompt_kernel_A_hi
  s_cmp_eq_u32 s44, 8
  s_cbranch_scc1 concat_heads__sliding_block__mha_block__prompt_kernel_A_lo
  s_waitcnt lgkmcnt(1)
  v_mfma_f32_32x32x16_bf16 v[52:67], v[124:127], v[150:153], v[20:35]
  s_branch concat_heads__sliding_block__mha_block__prompt_kernel_A_go
concat_heads__sliding_block__mha_block__prompt_kernel_A_hi:
  v_sub_f32 v108, v5, v36
  v_sub_f32 v109, v5, v37
  v_sub_f32 v110, v5, v38
  v_sub_f32 v111, v5, v39
  v_sub_f32 v112, v5, v40
  v_sub_f32 v113, v5, v41
  v_sub_f32 v114, v5, v42
  v_sub_f32 v115, v5, v43
  v_sub_f32 v116, v5, v44
  v_sub_f32 v117, v5, v45
  v_sub_f32 v118, v5, v46
  v_sub_f32 v119, v5, v47
  v_sub_f32 v120, v5, v48
  v_sub_f32 v121, v5, v49
  v_sub_f32 v122, v5, v50
  v_sub_f32 v123, v5, v51
  v_add_f32 v108, v108, v20
  v_add_f32 v109, v109, v21
  v_add_f32 v110, v110, v22
  v_add_f32 v111, v111, v23
  v_add_f32 v112, v112, v24
  v_add_f32 v113, v113, v25
  v_add_f32 v114, v114, v26
  v_add_f32 v115, v115, v27
  v_add_f32 v116, v116, v28
  v_add_f32 v117, v117, v29
  v_add_f32 v118, v118, v30
  v_add_f32 v119, v119, v31
  v_add_f32 v120, v120, v32
  v_add_f32 v121, v121, v33
  v_add_f32 v122, v122, v34
  v_add_f32 v123, v123, v35
  s_waitcnt lgkmcnt(1)
  v_mfma_f32_32x32x16_bf16 v[52:67], v[124:127], v[150:153], v[108:123]
  s_branch concat_heads__sliding_block__mha_block__prompt_kernel_A_go
concat_heads__sliding_block__mha_block__prompt_kernel_A_lo:
  v_add_f32 v108, v36, v20
  v_add_f32 v109, v37, v21
  v_add_f32 v110, v38, v22
  v_add_f32 v111, v39, v23
  v_add_f32 v112, v40, v24
  v_add_f32 v113, v41, v25
  v_add_f32 v114, v42, v26
  v_add_f32 v115, v43, v27
  v_add_f32 v116, v44, v28
  v_add_f32 v117, v45, v29
  v_add_f32 v118, v46, v30
  v_add_f32 v119, v47, v31
  v_add_f32 v120, v48, v32
  v_add_f32 v121, v49, v33
  v_add_f32 v122, v50, v34
  v_add_f32 v123, v51, v35
  s_waitcnt lgkmcnt(1)
  v_mfma_f32_32x32x16_bf16 v[52:67], v[124:127], v[150:153], v[108:123]
concat_heads__sliding_block__mha_block__prompt_kernel_A_go:
  v_mfma_f32_32x32x8_bf16 v[52:67], v[128:129], v[154:155], v[52:67]
  ds_read_b64 v[124:125], v140 offset:2624
  ds_read_b64 v[126:127], v140 offset:2880
  ds_read_b64 v[128:129], v141 offset:2624
  s_sub_u32 s46, 9, s44
  s_cmp_eq_u32 s46, 2
  s_cbranch_scc0 concat_heads__sliding_block__mha_block__prompt_kernel_A_c3
  s_nop 7
  v_add_f32 v20, v36, v20
  v_add_f32 v21, v37, v21
  v_add_f32 v22, v38, v22
  v_add_f32 v23, v39, v23
  v_add_f32 v24, v40, v24
  v_add_f32 v25, v41, v25
  v_add_f32 v26, v42, v26
  v_add_f32 v27, v43, v27
  v_add_f32 v28, v44, v28
  v_add_f32 v29, v45, v29
  v_add_f32 v30, v46, v30
  v_add_f32 v31, v47, v31
  v_add_f32 v32, v48, v32
  v_add_f32 v33, v49, v33
  v_add_f32 v34, v50, v34
  v_add_f32 v35, v51, v35
concat_heads__sliding_block__mha_block__prompt_kernel_A_c3:
  s_nop 9
concat_heads__sliding_block__mha_block__prompt_kernel_Aloop:
  v_exp_f32 v52, v52
  v_exp_f32 v53, v53
  v_mfma_f32_32x32x16_bf16 v[92:107], v[136:139], v[88:91], v[92:107]
  ds_read_b128 v[136:139], v142 offset:1952
  v_exp_f32 v54, v54
  v_exp_f32 v55, v55
  v_exp_f32 v56, v56
  v_exp_f32 v57, v57
  s_waitcnt lgkmcnt(1)
  v_mfma_f32_32x32x16_bf16 v[68:83], v[124:127], v[150:153], v[20:35]
  v_exp_f32 v58, v58
  v_exp_f32 v59, v59
  v_cvt_pk_bf16_f32 v84, v52, v53
  v_cvt_pk_bf16_f32 v85, v54, v55
  v_cvt_pk_bf16_f32 v86, v56, v57
  v_cvt_pk_bf16_f32 v87, v58, v59
  v_mfma_f32_32x32x8_bf16 v[68:83], v[128:129], v[154:155], v[68:83]
  ds_read_b64 v[124:125], v140 offset:5248
  ds_read_b64 v[126:127], v140 offset:5504
  ds_read_b64 v[128:129], v141 offset:5248
  v_exp_f32 v60, v60
  v_exp_f32 v61, v61
  v_exp_f32 v62, v62
  v_exp_f32 v63, v63
  v_mfma_f32_32x32x16_bf16 v[92:107], v[132:135], v[84:87], v[92:107]
  ds_read_b128 v[132:135], v142 offset:3904
  v_add_u32 v140, 2624, v140
  v_add_u32 v141, 2624, v141
  v_add_u32 v142, 2624, v142
  v_exp_f32 v64, v64
  v_exp_f32 v65, v65
  v_exp_f32 v66, v66
  v_exp_f32 v67, v67
  s_sub_u32 s46, s46, 1
  s_cmp_eq_u32 s46, 2
  s_cbranch_scc0 concat_heads__sliding_block__mha_block__prompt_kernel_A_m0
  v_add_f32 v20, v36, v20
  v_add_f32 v21, v37, v21
  v_add_f32 v22, v38, v22
  v_add_f32 v23, v39, v23
  v_add_f32 v24, v40, v24
  v_add_f32 v25, v41, v25
  v_add_f32 v26, v42, v26
  v_add_f32 v27, v43, v27
  v_add_f32 v28, v44, v28
  v_add_f32 v29, v45, v29
  v_add_f32 v30, v46, v30
  v_add_f32 v31, v47, v31
  v_add_f32 v32, v48, v32
  v_add_f32 v33, v49, v33
  v_add_f32 v34, v50, v34
  v_add_f32 v35, v51, v35
concat_heads__sliding_block__mha_block__prompt_kernel_A_m0:
  v_cvt_pk_bf16_f32 v88, v60, v61
  v_cvt_pk_bf16_f32 v89, v62, v63
  v_cvt_pk_bf16_f32 v90, v64, v65
  v_cvt_pk_bf16_f32 v91, v66, v67
  s_waitcnt lgkmcnt(4)
  s_cmp_eq_u32 s46, 0
  s_cbranch_scc1 concat_heads__sliding_block__mha_block__prompt_kernel_Adone
  v_exp_f32 v68, v68
  v_exp_f32 v69, v69
  v_mfma_f32_32x32x16_bf16 v[92:107], v[136:139], v[88:91], v[92:107]
  ds_read_b128 v[136:139], v142 offset:1952
  v_exp_f32 v70, v70
  v_exp_f32 v71, v71
  v_exp_f32 v72, v72
  v_exp_f32 v73, v73
  s_waitcnt lgkmcnt(1)
  v_mfma_f32_32x32x16_bf16 v[52:67], v[124:127], v[150:153], v[20:35]
  v_exp_f32 v74, v74
  v_exp_f32 v75, v75
  v_cvt_pk_bf16_f32 v84, v68, v69
  v_cvt_pk_bf16_f32 v85, v70, v71
  v_cvt_pk_bf16_f32 v86, v72, v73
  v_cvt_pk_bf16_f32 v87, v74, v75
  v_mfma_f32_32x32x8_bf16 v[52:67], v[128:129], v[154:155], v[52:67]
  ds_read_b64 v[124:125], v140 offset:5248
  ds_read_b64 v[126:127], v140 offset:5504
  ds_read_b64 v[128:129], v141 offset:5248
  v_exp_f32 v76, v76
  v_exp_f32 v77, v77
  v_exp_f32 v78, v78
  v_exp_f32 v79, v79
  v_mfma_f32_32x32x16_bf16 v[92:107], v[132:135], v[84:87], v[92:107]
  ds_read_b128 v[132:135], v142 offset:3904
  v_add_u32 v140, 2624, v140
  v_add_u32 v141, 2624, v141
  v_add_u32 v142, 2624, v142
  v_exp_f32 v80, v80
  v_exp_f32 v81, v81
  v_exp_f32 v82, v82
  v_exp_f32 v83, v83
  s_sub_u32 s46, s46, 1
  s_cmp_eq_u32 s46, 2
  s_cbranch_scc0 concat_heads__sliding_block__mha_block__prompt_kernel_A_m1
  v_add_f32 v20, v36, v20
  v_add_f32 v21, v37, v21
  v_add_f32 v22, v38, v22
  v_add_f32 v23, v39, v23
  v_add_f32 v24, v40, v24
  v_add_f32 v25, v41, v25
  v_add_f32 v26, v42, v26
  v_add_f32 v27, v43, v27
  v_add_f32 v28, v44, v28
  v_add_f32 v29, v45, v29
  v_add_f32 v30, v46, v30
  v_add_f32 v31, v47, v31
  v_add_f32 v32, v48, v32
  v_add_f32 v33, v49, v33
  v_add_f32 v34, v50, v34
  v_add_f32 v35, v51, v35
concat_heads__sliding_block__mha_block__prompt_kernel_A_m1:
  v_cvt_pk_bf16_f32 v88, v76, v77
  v_cvt_pk_bf16_f32 v89, v78, v79
  v_cvt_pk_bf16_f32 v90, v80, v81
  v_cvt_pk_bf16_f32 v91, v82, v83
  s_waitcnt lgkmcnt(4)
  s_cmp_eq_u32 s46, 0
  s_cbranch_scc1 concat_heads__sliding_block__mha_block__prompt_kernel_Adone
  s_branch concat_heads__sliding_block__mha_block__prompt_kernel_Aloop
concat_heads__sliding_block__mha_block__prompt_kernel_Adone:
  s_nop 1
  v_mfma_f32_32x32x16_bf16 v[92:107], v[136:139], v[88:91], v[92:107]
  s_waitcnt lgkmcnt(0)
  s_mov_b64 s[54:55], 0
  s_nop 15
  v_mov_b32 v156, v100
  v_mov_b32 v157, v100
  s_nop 1
  v_permlane32_swap_b32 v156, v157
  s_nop 1
  v_rcp_f32 v156, v157
  v_cmp_nlt_f32 vcc, v157, v167
  v_mul_f32 v92, v92, v156
  v_mul_f32 v93, v93, v156
  v_mul_f32 v94, v94, v156
  v_mul_f32 v95, v95, v156
  v_mul_f32 v96, v96, v156
  v_mul_f32 v97, v97, v156
  v_mul_f32 v98, v98, v156
  v_mul_f32 v99, v99, v156
  v_mul_f32 v100, v100, v156
  v_mul_f32 v101, v101, v156
  v_mul_f32 v102, v102, v156
  v_mul_f32 v103, v103, v156
  s_or_b64 s[54:55], s[54:55], vcc
  v_cvt_pk_bf16_f32 v158, v92, v93
  v_cvt_pk_bf16_f32 v159, v94, v95
  v_cvt_pk_bf16_f32 v160, v96, v97
  v_cvt_pk_bf16_f32 v161, v98, v99
  v_cvt_pk_bf16_f32 v162, v100, v101
  v_cvt_pk_bf16_f32 v163, v102, v103
  v_add_f32 v157, |v92|, |v93|
  v_add_f32 v157, |v94|, v157
  v_add_f32 v157, |v95|, v157
  v_add_f32 v157, |v96|, v157
  v_add_f32 v157, |v97|, v157
  v_add_f32 v157, |v98|, v157
  v_add_f32 v157, |v99|, v157
  v_add_f32 v157, |v100|, v157
  v_add_f32 v157, |v101|, v157
  v_add_f32 v157, |v102|, v157
  v_add_f32 v157, |v103|, v157
  v_cmp_nlt_f32 vcc, v157, v167
  s_add_u32 s60, s57, 0
  s_mul_i32 s60, s60, 40960
  s_add_u32 s60, s60, 16777216
  s_add_u32 s61, s60, s59
  s_add_u32 s60, s60, s58
  s_or_b64 s[54:55], s[54:55], vcc
  buffer_store_dwordx4 v[158:161], v148, s[12:15], s60 offen sc1
  buffer_store_dwordx2 v[162:163], v149, s[12:15], s61 offen sc1
  s_cmp_eq_u64 s[54:55], 0
  s_cbranch_scc1 concat_heads__sliding_block__mha_block__prompt_kernel_Aok
  s_cmp_eq_u32 s51, 1
  s_cbranch_scc1 concat_heads__sliding_block__mha_block__prompt_kernel_Aok
  s_mov_b32 s51, 1
  v_mov_b32 v156, 0xf149f2ca
  s_mov_b32 s46, s44
  s_mov_b32 s47, s45
concat_heads__sliding_block__mha_block__prompt_kernel_A1:
  v_add_u32 v140, s47, v143
  v_add_u32 v141, s47, v144
  ds_read_b64 v[124:125], v140 offset:0
  ds_read_b64 v[126:127], v140 offset:256
  ds_read_b64 v[128:129], v141 offset:0
  v_mov_b32 v108, 0
  v_mov_b32 v109, 0
  v_mov_b32 v110, 0
  v_mov_b32 v111, 0
  v_mov_b32 v112, 0
  v_mov_b32 v113, 0
  v_mov_b32 v114, 0
  v_mov_b32 v115, 0
  v_mov_b32 v116, 0
  v_mov_b32 v117, 0
  v_mov_b32 v118, 0
  v_mov_b32 v119, 0
  v_mov_b32 v120, 0
  v_mov_b32 v121, 0
  v_mov_b32 v122, 0
  v_mov_b32 v123, 0
  s_cmp_eq_u32 s46, 0
  s_cbranch_scc0 concat_heads__sliding_block__mha_block__prompt_kernel_A1a
  v_sub_f32 v108, v5, v36
  v_sub_f32 v109, v5, v37
  v_sub_f32 v110, v5, v38
  v_sub_f32 v111, v5, v39
  v_sub_f32 v112, v5, v40
  v_sub_f32 v113, v5, v41
  v_sub_f32 v114, v5, v42
  v_sub_f32 v115, v5, v43
  v_sub_f32 v116, v5, v44
  v_sub_f32 v117, v5, v45
  v_sub_f32 v118, v5, v46
  v_sub_f32 v119, v5, v47
  v_sub_f32 v120, v5, v48
  v_sub_f32 v121, v5, v49
  v_sub_f32 v122, v5, v50
  v_sub_f32 v123, v5, v51
concat_heads__sliding_block__mha_block__prompt_kernel_A1a:
  s_cmp_eq_u32 s46, 8
  s_cbranch_scc0 concat_heads__sliding_block__mha_block__prompt_kernel_A1b
  v_mov_b32 v108, v36
  v_mov_b32 v109, v37
  v_mov_b32 v110, v38
  v_mov_b32 v111, v39
  v_mov_b32 v112, v40
  v_mov_b32 v113, v41
  v_mov_b32 v114, v42
  v_mov_b32 v115, v43
  v_mov_b32 v116, v44
  v_mov_b32 v117, v45
  v_mov_b32 v118, v46
  v_mov_b32 v119, v47
  v_mov_b32 v120, v48
  v_mov_b32 v121, v49
  v_mov_b32 v122, v50
  v_mov_b32 v123, v51
concat_heads__sliding_block__mha_block__prompt_kernel_A1b:
  s_waitcnt lgkmcnt(0)
  s_nop 1
  v_mfma_f32_32x32x16_bf16 v[52:67], v[124:127], v[150:153], v[108:123]
  v_mfma_f32_32x32x8_bf16 v[52:67], v[128:129], v[154:155], v[52:67]
  s_nop 15
  v_max3_f32 v156, v52, v53, v156
  v_max3_f32 v156, v54, v55, v156
  v_max3_f32 v156, v56, v57, v156
  v_max3_f32 v156, v58, v59, v156
  v_max3_f32 v156, v60, v61, v156
  v_max3_f32 v156, v62, v63, v156
  v_max3_f32 v156, v64, v65, v156
  v_max3_f32 v156, v66, v67, v156
  s_add_u32 s47, s47, 2624
  s_add_u32 s46, s46, 1
  s_cmp_le_u32 s46, 8
  s_cbranch_scc1 concat_heads__sliding_block__mha_block__prompt_kernel_A1
  v_mov_b32 v158, v156
  v_mov_b32 v159, v156
  s_nop 1
  v_permlane32_swap_b32 v158, v159
  s_nop 1
  v_max_f32 v156, v158, v159
  s_branch concat_heads__sliding_block__mha_block__prompt_kernel_Astart
concat_heads__sliding_block__mha_block__prompt_kernel_Aok:
  s_waitcnt vmcnt(0) lgkmcnt(0)
  s_barrier
  v_mov_b32 v2, 125440
  ds_read_b32 v3, v2
  s_waitcnt lgkmcnt(0)
  v_readfirstlane_b32 s44, v3
  s_nop 3
  s_cmp_eq_u32 s44, 0
  s_cbranch_scc1 concat_heads__sliding_block__mha_block__prompt_kernel_fin2
  s_mov_b32 s50, 1
  v_mov_b32 v156, 0xf149f2ca
  v_mov_b32 v157, 0xf149f2ca
  s_barrier
  s_mov_b32 s41, 0
  s_mov_b32 s42, 0
concat_heads__sliding_block__mha_block__prompt_kernel_Mloop:
  s_add_u32 s43, s42, s40
  s_mov_b32 s45, 0
concat_heads__sliding_block__mha_block__prompt_kernel_Mtile:
  v_add_u32 v140, s43, v143
  v_add_u32 v141, s43, v144
  ds_read_b64 v[124:125], v140 offset:0
  ds_read_b64 v[126:127], v140 offset:256
  ds_read_b64 v[128:129], v141 offset:0
  s_waitcnt lgkmcnt(0)
  v_mfma_f32_32x32x16_bf16 v[52:67], v[124:127], v[8:11], 0
  v_mfma_f32_32x32x16_bf16 v[68:83], v[124:127], v[14:17], 0
  v_mfma_f32_32x32x8_bf16 v[52:67], v[128:129], v[12:13], v[52:67]
  v_mfma_f32_32x32x8_bf16 v[68:83], v[128:129], v[18:19], v[68:83]
  s_nop 15
  v_max3_f32 v156, v52, v53, v156
  v_max3_f32 v156, v54, v55, v156
  v_max3_f32 v156, v56, v57, v156
  v_max3_f32 v156, v58, v59, v156
  v_max3_f32 v156, v60, v61, v156
  v_max3_f32 v156, v62, v63, v156
  v_max3_f32 v156, v64, v65, v156
  v_max3_f32 v156, v66, v67, v156
  v_max3_f32 v157, v68, v69, v157
  v_max3_f32 v157, v70, v71, v157
  v_max3_f32 v157, v72, v73, v157
  v_max3_f32 v157, v74, v75, v157
  v_max3_f32 v157, v76, v77, v157
  v_max3_f32 v157, v78, v79, v157
  v_max3_f32 v157, v80, v81, v157
  v_max3_f32 v157, v82, v83, v157
  s_add_u32 s43, s43, 2624
  s_add_u32 s45, s45, 1
  s_cmp_lt_u32 s45, 4
  s_cbranch_scc1 concat_heads__sliding_block__mha_block__prompt_kernel_Mtile
  s_add_u32 s42, s42, 20992
  s_cmp_eq_u32 s42, 62976
  s_cselect_b32 s42, 0, s42
  s_add_u32 s41, s41, 1
  s_cmp_eq_u32 s41, 8
  s_cbranch_scc1 concat_heads__sliding_block__mha_block__prompt_kernel_Mdone
  s_barrier
  s_branch concat_heads__sliding_block__mha_block__prompt_kernel_Mloop
concat_heads__sliding_block__mha_block__prompt_kernel_Mdone:
  v_mov_b32 v158, v156
  v_mov_b32 v159, v156
  s_nop 1
  v_permlane32_swap_b32 v158, v159
  s_nop 1
  v_max_f32 v156, v158, v159
  v_mov_b32 v158, v157
  v_mov_b32 v159, v157
  s_nop 1
  v_permlane32_swap_b32 v158, v159
  s_nop 1
  v_max_f32 v157, v158, v159
  v_lshlrev_b32 v2, 2, v1
  s_lshl_b32 s44, s32, 9
  s_add_u32 s44, s44, 125696
  v_add_u32 v3, s44, v2
  ds_write_b32 v3, v156
  ds_write_b32 v3, v157 offset:256
  s_waitcnt lgkmcnt(0)
  s_barrier
  s_xor_b32 s44, s32, 4
  s_lshl_b32 s44, s44, 9
  s_add_u32 s44, s44, 125696
  v_add_u32 v3, s44, v2
  ds_read_b32 v158, v3
  ds_read_b32 v159, v3 offset:256
  s_waitcnt lgkmcnt(0)
  v_max_f32 v156, v156, v158
  v_max_f32 v157, v157, v159
  s_barrier
  v_mov_b32 v92, 0
  v_mov_b32 v93, 0
  v_mov_b32 v94, 0
  v_mov_b32 v95, 0
  v_mov_b32 v96, 0
  v_mov_b32 v97, 0
  v_mov_b32 v98, 0
  v_mov_b32 v99, 0
  v_mov_b32 v100, 0
  v_mov_b32 v101, 0
  v_mov_b32 v102, 0
  v_mov_b32 v103, 0
  v_mov_b32 v104, 0
  v_mov_b32 v105, 0
  v_mov_b32 v106, 0
  v_mov_b32 v107, 0
  v_mov_b32 v108, 0
  v_mov_b32 v109, 0
  v_mov_b32 v110, 0
  v_mov_b32 v111, 0
  v_mov_b32 v112, 0
  v_mov_b32 v113, 0
  v_mov_b32 v114, 0
  v_mov_b32 v115, 0
  v_mov_b32 v116, 0
  v_mov_b32 v117, 0
  v_mov_b32 v118, 0
  v_mov_b32 v119, 0
  v_mov_b32 v120, 0
  v_mov_b32 v121, 0
  v_mov_b32 v122, 0
  v_mov_b32 v123, 0
  v_mov_b32 v84, 0
  v_mov_b32 v85, 0
  v_mov_b32 v86, 0
  v_mov_b32 v87, 0
  v_mov_b32 v88, 0
  v_mov_b32 v89, 0
  v_mov_b32 v90, 0
  v_mov_b32 v91, 0
  v_mov_b32 v136, 0
  v_mov_b32 v137, 0
  v_mov_b32 v138, 0
  v_mov_b32 v139, 0
  s_mov_b32 s50, 2
  s_barrier
  s_branch concat_heads__sliding_block__mha_block__prompt_kernel_Bstart
concat_heads__sliding_block__mha_block__prompt_kernel_fin:
  s_waitcnt vmcnt(0)
  s_barrier
concat_heads__sliding_block__mha_block__prompt_kernel_fin2:
  s_and_b32 s37, s2, 7
  s_lshr_b32 s38, s2, 3
  s_lshr_b32 s34, s37, 2
  s_and_b32 s35, s37, 3
  s_lshl_b32 s35, s35, 3
  s_lshr_b32 s36, s38, 2
  s_add_u32 s35, s35, s36
  s_and_b32 s36, s38, 3
  s_cmp_ge_u32 s32, 6
  s_cbranch_scc0 concat_heads__sliding_block__mha_block__prompt_kernel_oc
  s_barrier
  s_barrier
  s_barrier
  s_barrier
  s_barrier
  s_barrier
  s_barrier
  s_barrier
  s_barrier
  s_barrier
  s_barrier
  s_endpgm
concat_heads__sliding_block__mha_block__prompt_kernel_oc:
  s_mov_b32 s4, s28
  s_and_b32 s5, s29, 0xffff
  s_mov_b32 s6, 5242880
  s_mov_b32 s7, 0x20000
  s_min_u32 s39, s32, 4
  s_sub_u32 s40, s32, 4
  s_max_i32 s40, s40, 0
  v_lshrrev_b32 v3, 5, v1
  v_bfe_u32 v4, v1, 2, 2
  v_lshl_add_u32 v5, v3, 3, v4
  v_mul_u32_u24 v5, 320, v5
  v_bfe_u32 v6, v1, 4, 1
  v_lshl_add_u32 v5, v6, 5, v5
  v_and_b32 v6, 3, v1
  v_lshl_add_u32 v5, v6, 3, v5
  s_lshl_b32 s41, s39, 6
  v_add_u32 v10, s41, v5
  s_mul_i32 s41, s40, 40960
  s_add_u32 s41, s41, 81920
  v_lshlrev_b32 v5, 4, v1
  v_add_u32 v13, s41, v5
  v_mov_b32 v32, 0
  v_mov_b32 v33, 0
  v_mov_b32 v34, 0
  v_mov_b32 v35, 0
  v_mov_b32 v36, 0
  v_mov_b32 v37, 0
  v_mov_b32 v38, 0
  v_mov_b32 v39, 0
  v_mov_b32 v40, 0
  v_mov_b32 v41, 0
  v_mov_b32 v42, 0
  v_mov_b32 v43, 0
  v_mov_b32 v44, 0
  v_mov_b32 v45, 0
  v_mov_b32 v46, 0
  v_mov_b32 v47, 0
  v_mov_b32 v48, 0
  v_mov_b32 v49, 0
  v_mov_b32 v50, 0
  v_mov_b32 v51, 0
  v_mov_b32 v52, 0
  v_mov_b32 v53, 0
  v_mov_b32 v54, 0
  v_mov_b32 v55, 0
  v_mov_b32 v56, 0
  v_mov_b32 v57, 0
  v_mov_b32 v58, 0
  v_mov_b32 v59, 0
  v_mov_b32 v60, 0
  v_mov_b32 v61, 0
  v_mov_b32 v62, 0
  v_mov_b32 v63, 0
  v_mov_b32 v76, 0
  v_mov_b32 v77, 0
  v_mov_b32 v78, 0
  v_mov_b32 v79, 0
  v_mov_b32 v80, 0
  v_mov_b32 v81, 0
  v_mov_b32 v82, 0
  v_mov_b32 v83, 0
  v_mov_b32 v84, 0
  v_mov_b32 v85, 0
  v_mov_b32 v86, 0
  v_mov_b32 v87, 0
  s_mov_b32 s42, 0
  s_mov_b32 s43, 0
  s_lshl_b32 s44, s35, 6
  s_lshl_b32 s45, s40, 5
  s_add_u32 s44, s44, s45
  v_and_b32 v2, 31, v1
  v_add_u32 v2, s44, v2
  s_movk_i32 s45, 2560
  v_mul_lo_u32 v2, v2, s45
  v_lshl_add_u32 v14, v3, 4, v2
  s_mul_i32 s46, s34, 1280
  s_mul_i32 s47, s36, 320
  s_add_u32 s46, s46, s47
  s_lshl_b32 s47, s39, 6
  s_add_u32 s46, s46, s47
  s_add_u32 s47, s46, 81920
  s_barrier
  s_cmp_ge_u32 s32, 4
  s_cbranch_scc1 concat_heads__sliding_block__mha_block__prompt_kernel_o1
.p2align 6
concat_heads__sliding_block__mha_block__prompt_kernel_o2_loop:
  v_add_u32 v12, s42, v10
  s_barrier
  ds_read_b64_tr_b16 v[64:65], v12 offset:0
  ds_read_b64_tr_b16 v[66:67], v12 offset:1280
  ds_read_b128 v[68:71], v13 offset:0
  ds_read_b128 v[72:75], v13 offset:40960
  v_mfma_f32_32x32x16_bf16 v[32:47], v[76:79], v[80:83], v[32:47]
  v_mfma_f32_32x32x16_bf16 v[48:63], v[76:79], v[84:87], v[48:63]
  ds_read_b64_tr_b16 v[76:77], v12 offset:5120
  ds_read_b64_tr_b16 v[78:79], v12 offset:6400
  ds_read_b128 v[80:83], v13 offset:1024
  ds_read_b128 v[84:87], v13 offset:41984
  s_waitcnt lgkmcnt(4)
  v_mfma_f32_32x32x16_bf16 v[32:47], v[64:67], v[68:71], v[32:47]
  v_mfma_f32_32x32x16_bf16 v[48:63], v[64:67], v[72:75], v[48:63]
  ds_read_b64_tr_b16 v[64:65], v12 offset:10240
  ds_read_b64_tr_b16 v[66:67], v12 offset:11520
  ds_read_b128 v[68:71], v13 offset:2048
  ds_read_b128 v[72:75], v13 offset:43008
  s_waitcnt lgkmcnt(4)
  v_mfma_f32_32x32x16_bf16 v[32:47], v[76:79], v[80:83], v[32:47]
  v_mfma_f32_32x32x16_bf16 v[48:63], v[76:79], v[84:87], v[48:63]
  ds_read_b64_tr_b16 v[76:77], v12 offset:15360
  ds_read_b64_tr_b16 v[78:79], v12 offset:16640
  ds_read_b128 v[80:83], v13 offset:3072
  ds_read_b128 v[84:87], v13 offset:44032
  s_waitcnt lgkmcnt(4)
  v_mfma_f32_32x32x16_bf16 v[32:47], v[64:67], v[68:71], v[32:47]
  v_mfma_f32_32x32x16_bf16 v[48:63], v[64:67], v[72:75], v[48:63]
  v_add_u32 v13, 4096, v13
  s_add_u32 s42, s42, 20480
  s_cmp_eq_u32 s42, 81920
  s_cselect_b32 s42, 0, s42
  s_add_u32 s43, s43, 1
  s_cmp_lt_u32 s43, 10
  s_waitcnt lgkmcnt(0)
  s_cbranch_scc1 concat_heads__sliding_block__mha_block__prompt_kernel_o2_loop
  v_mfma_f32_32x32x16_bf16 v[32:47], v[76:79], v[80:83], v[32:47]
  v_mfma_f32_32x32x16_bf16 v[48:63], v[76:79], v[84:87], v[48:63]
  s_nop 15
  v_cvt_pk_bf16_f32 v16, v32, v33
  v_cvt_pk_bf16_f32 v17, v34, v35
  v_cvt_pk_bf16_f32 v18, v36, v37
  v_cvt_pk_bf16_f32 v19, v38, v39
  s_nop 1
  v_permlane32_swap_b32 v16, v18
  v_permlane32_swap_b32 v17, v19
  s_nop 1
  buffer_store_dwordx4 v[16:19], v14, s[4:7], s46 offen offset:0
  v_cvt_pk_bf16_f32 v20, v40, v41
  v_cvt_pk_bf16_f32 v21, v42, v43
  v_cvt_pk_bf16_f32 v22, v44, v45
  v_cvt_pk_bf16_f32 v23, v46, v47
  s_nop 1
  v_permlane32_swap_b32 v20, v22
  v_permlane32_swap_b32 v21, v23
  s_nop 1
  buffer_store_dwordx4 v[20:23], v14, s[4:7], s46 offen offset:32
  v_cvt_pk_bf16_f32 v24, v48, v49
  v_cvt_pk_bf16_f32 v25, v50, v51
  v_cvt_pk_bf16_f32 v26, v52, v53
  v_cvt_pk_bf16_f32 v27, v54, v55
  s_nop 1
  v_permlane32_swap_b32 v24, v26
  v_permlane32_swap_b32 v25, v27
  s_nop 1
  buffer_store_dwordx4 v[24:27], v14, s[4:7], s47 offen offset:0
  v_cvt_pk_bf16_f32 v28, v56, v57
  v_cvt_pk_bf16_f32 v29, v58, v59
  v_cvt_pk_bf16_f32 v30, v60, v61
  v_cvt_pk_bf16_f32 v31, v62, v63
  s_nop 1
  v_permlane32_swap_b32 v28, v30
  v_permlane32_swap_b32 v29, v31
  s_nop 1
  buffer_store_dwordx4 v[28:31], v14, s[4:7], s47 offen offset:32
  s_endpgm
concat_heads__sliding_block__mha_block__prompt_kernel_o1:
.p2align 6
concat_heads__sliding_block__mha_block__prompt_kernel_o1_loop:
  v_add_u32 v12, s42, v10
  s_barrier
  ds_read_b64_tr_b16 v[64:65], v12 offset:0
  ds_read_b64_tr_b16 v[66:67], v12 offset:1280
  ds_read_b128 v[68:71], v13 offset:0
  v_mfma_f32_32x32x16_bf16 v[32:47], v[76:79], v[80:83], v[32:47]
  ds_read_b64_tr_b16 v[76:77], v12 offset:5120
  ds_read_b64_tr_b16 v[78:79], v12 offset:6400
  ds_read_b128 v[80:83], v13 offset:1024
  s_waitcnt lgkmcnt(3)
  v_mfma_f32_32x32x16_bf16 v[32:47], v[64:67], v[68:71], v[32:47]
  ds_read_b64_tr_b16 v[64:65], v12 offset:10240
  ds_read_b64_tr_b16 v[66:67], v12 offset:11520
  ds_read_b128 v[68:71], v13 offset:2048
  s_waitcnt lgkmcnt(3)
  v_mfma_f32_32x32x16_bf16 v[32:47], v[76:79], v[80:83], v[32:47]
  ds_read_b64_tr_b16 v[76:77], v12 offset:15360
  ds_read_b64_tr_b16 v[78:79], v12 offset:16640
  ds_read_b128 v[80:83], v13 offset:3072
  s_waitcnt lgkmcnt(3)
  v_mfma_f32_32x32x16_bf16 v[32:47], v[64:67], v[68:71], v[32:47]
  v_add_u32 v13, 4096, v13
  s_add_u32 s42, s42, 20480
  s_cmp_eq_u32 s42, 81920
  s_cselect_b32 s42, 0, s42
  s_add_u32 s43, s43, 1
  s_cmp_lt_u32 s43, 10
  s_waitcnt lgkmcnt(0)
  s_cbranch_scc1 concat_heads__sliding_block__mha_block__prompt_kernel_o1_loop
  v_mfma_f32_32x32x16_bf16 v[32:47], v[76:79], v[80:83], v[32:47]
  s_nop 15
  v_cvt_pk_bf16_f32 v16, v32, v33
  v_cvt_pk_bf16_f32 v17, v34, v35
  v_cvt_pk_bf16_f32 v18, v36, v37
  v_cvt_pk_bf16_f32 v19, v38, v39
  s_nop 1
  v_permlane32_swap_b32 v16, v18
  v_permlane32_swap_b32 v17, v19
  s_nop 1
  buffer_store_dwordx4 v[16:19], v14, s[4:7], s46 offen offset:0
  v_cvt_pk_bf16_f32 v20, v40, v41
  v_cvt_pk_bf16_f32 v21, v42, v43
  v_cvt_pk_bf16_f32 v22, v44, v45
  v_cvt_pk_bf16_f32 v23, v46, v47
  s_nop 1
  v_permlane32_swap_b32 v20, v22
  v_permlane32_swap_b32 v21, v23
  s_nop 1
  buffer_store_dwordx4 v[20:23], v14, s[4:7], s46 offen offset:32
  s_endpgm
concat_heads__sliding_block__mha_block__prompt_kernel_END:
  s_endpgm
.section .rodata,"a"
.p2align 6
.amdhsa_kernel concat_heads__sliding_block__mha_block__prompt_kernel
  .amdhsa_next_free_vgpr 168
  .amdhsa_next_free_sgpr 102
  .amdhsa_accum_offset 168
  .amdhsa_group_segment_fixed_size 0
  .amdhsa_kernarg_size 72
  .amdhsa_user_sgpr_count 2
  .amdhsa_user_sgpr_kernarg_segment_ptr 1
  .amdhsa_system_sgpr_workgroup_id_x 1
.end_amdhsa_kernel
```
